```python
import torch

def _softmax(x, axis=-1):
    return torch.softmax(x, dim=axis)
def _gelu(x):
    return torch.nn.functional.gelu(x, approximate="tanh")
def _silu(x):
    return torch.nn.functional.silu(x)
def _sigmoid(x):
    return torch.sigmoid(x)
def _layernorm(x, axis=-1, eps=1e-5):
    m = x.mean(dim=axis, keepdim=True)
    v = x.var(dim=axis, keepdim=True, unbiased=False)
    return (x - m) / torch.sqrt(v + eps)
def _scatter_add(tgt, idx, src, axis=0):
    return tgt.clone().index_add_(axis, idx, src)
def _segment_sum(src, seg, n):
    out = torch.zeros((n,) + src.shape[1:], dtype=src.dtype)
    return out.index_add_(0, seg, src)
def _pad(x, pw):
    flat = tuple(v for pair in reversed(pw) for v in pair)
    return torch.nn.functional.pad(x, flat)

kernel_name = 'standalone__gqa_block_cached__near_ridge'

def setup_inputs():

    _w = (lambda a: (lambda t: t.to(torch.bfloat16) if t.is_floating_point() else t)(torch.as_tensor(a)))
    B, Sq, D = 16, 64, 576
    Hq, Hkv, Sk, Dh = 32, 16, 1024, 128
    assert Hq % Hkv == 0, (Hq, Hkv)
    return {
        "x": _w((lambda *s: torch.randn(*s, dtype=torch.bfloat16) * 0.8)(B, Sq, D)),
        "k_cache": _w((lambda *s: torch.randn(*s, dtype=torch.bfloat16) * 0.8)(B, Hkv, Sk, Dh)),
        "v_cache": _w((lambda *s: torch.randn(*s, dtype=torch.bfloat16) * 0.05)(B, Hkv, Sk, Dh)),
        "wq": _w((lambda *s: torch.randn(*s, dtype=torch.bfloat16) * 0.8)(D, Hq * Dh) * (D ** -0.5)),
        "wo": _w((lambda *s: torch.randn(*s, dtype=torch.bfloat16) * 0.05)(Hq * Dh, D) * ((Hq * Dh) ** -0.5)),
    }

def reference(x, k_cache, v_cache, wq, wo):
    B, Sq, D = x.shape
    Hq, Dh = 32, 128
    Hkv = k_cache.shape[1]
    rep = Hq // Hkv
    q = (lambda x, *d: x.permute(*d))((x @ wq).reshape(B, Sq, Hq, Dh), 0, 2, 1, 3)
    k = (lambda x, n, axis: torch.repeat_interleave(x, n, dim=axis))(k_cache, rep, axis=1)
    v = (lambda x, n, axis: torch.repeat_interleave(x, n, dim=axis))(v_cache, rep, axis=1)
    scores = torch.einsum("bhqd,bhkd->bhqk", q, k) * (Dh ** -0.5)
    p = _softmax(scores, axis=-1)
    o = torch.einsum("bhqk,bhkd->bhqd", p, v)
    return (lambda x, *d: x.permute(*d))(o, 0, 2, 1, 3).reshape(B, Sq, Hq * Dh) @ wo
```

```asm
; @launch kernel=attn_kernel grid=(256,1,1) block=(768,1,1) lds=163840
; @launch kernel=oproj_kernel grid=(144,1,1) block=(512,1,1) lds=131072
.amdgcn_target "amdgcn-amd-amdhsa--gfx950"
.text
.globl attn_kernel
.p2align 8
.type attn_kernel,@function
attn_kernel:
    s_cmp_ge_u32 s2, 256
    s_cbranch_scc1 attn_end
    s_load_dwordx4 s[4:7], s[0:1], 0
    s_load_dwordx4 s[8:11], s[0:1], 16
    s_load_dwordx2 s[16:17], s[0:1], 56
    s_load_dwordx2 s[12:13], s[0:1], 32
    v_and_b32 v1, 63, v0
    v_lshrrev_b32 v2, 6, v0
    s_nop 0
    v_readfirstlane_b32 s40, v2
    s_and_b32 s41, s2, 15
    s_lshr_b32 s42, s2, 4
    s_add_u32 s50, s41, s42
    s_waitcnt lgkmcnt(0)
    s_lshl_b32 s43, s41, 9
    s_add_u32 s32, s10, s43
    s_addc_u32 s33, s11, 0
    s_sub_u32 s34, 4718592, s43
    s_mov_b32 s35, 0x20000
    v_lshrrev_b32 v2, 5, v1
    v_and_b32 v3, 31, v1
    v_lshlrev_b32 v4, 13, v2
    v_add_u32 v5, 0, v2
    v_lshlrev_b32 v5, 2, v5
    v_xor_b32 v5, v5, v3
    v_lshl_add_u32 v166, v5, 4, v4
    v_add_u32 v5, 2, v2
    v_lshlrev_b32 v5, 2, v5
    v_xor_b32 v5, v5, v3
    v_lshl_add_u32 v167, v5, 4, v4
    s_cmp_ge_u32 s40, 8
    s_cbranch_scc1 attn_loader
    s_add_u32 s43, s40, 8
    s_lshl_b32 s52, s43, 14
    s_lshl_b32 s53, s43, 10
    s_add_u32 s53, s53, 32768
    s_and_b32 s43, s40, 1
    s_cmp_eq_u32 s43, 0
    s_cbranch_scc1 attn_weven
    v_mov_b32 v166, v167
attn_weven:
    s_and_b32 s72, s40, 3
    s_lshr_b32 s73, s40, 2
    s_mul_i32 s43, s42, 73728
    s_add_u32 s28, s4, s43
    s_addc_u32 s29, s5, 0
    s_mov_b32 s30, 73728
    s_mov_b32 s31, 0x20000
    s_mov_b32 s36, s16
    s_mov_b32 s37, s17
    s_mov_b32 s38, 0x800000
    s_mov_b32 s39, 0x20000
    s_and_b32 s43, s72, 1
    s_lshl_b32 s43, s43, 5
    v_and_b32 v2, 31, v1
    v_add_u32 v2, s43, v2
    v_lshlrev_b32 v2, 6, v2
    v_add_u32 v2, 49152, v2
    v_lshrrev_b32 v3, 5, v1
    v_bfe_u32 v4, v1, 2, 2
    v_xor_b32 v3, v3, v4
    v_xor_b32 v4, 0, v3
    v_lshl_add_u32 v88, v4, 4, v2
    v_add_u32 v90, 61440, v88
    v_xor_b32 v4, 2, v3
    v_lshl_add_u32 v89, v4, 4, v2
    v_add_u32 v91, 61440, v89
    s_add_u32 s46, s42, 0
    s_sub_u32 s43, s46, 18
    s_cmp_ge_u32 s46, 18
    s_cselect_b32 s46, s43, s46
    s_lshl_b32 s46, s46, 18
    s_add_u32 s46, s46, s52
    s_add_u32 m0, s53, 40960
    s_nop 0
    buffer_load_dwordx4 v166, s[32:35], s46 offen lds
    s_add_u32 s46, s42, 1
    s_sub_u32 s43, s46, 18
    s_cmp_ge_u32 s46, 18
    s_cselect_b32 s46, s43, s46
    s_lshl_b32 s46, s46, 18
    s_add_u32 s46, s46, s52
    s_add_u32 m0, s53, 61440
    s_nop 0
    buffer_load_dwordx4 v166, s[32:35], s46 offen lds
    s_add_u32 s46, s42, 2
    s_sub_u32 s43, s46, 18
    s_cmp_ge_u32 s46, 18
    s_cselect_b32 s46, s43, s46
    s_lshl_b32 s46, s46, 18
    s_add_u32 s46, s46, s52
    s_add_u32 m0, s53, 81920
    s_nop 0
    buffer_load_dwordx4 v166, s[32:35], s46 offen lds
    s_add_u32 s46, s42, 3
    s_sub_u32 s43, s46, 18
    s_cmp_ge_u32 s46, 18
    s_cselect_b32 s46, s43, s46
    s_lshl_b32 s46, s46, 18
    s_add_u32 s46, s46, s52
    s_add_u32 m0, s53, 102400
    s_nop 0
    buffer_load_dwordx4 v166, s[32:35], s46 offen lds
    s_add_u32 s46, s42, 4
    s_sub_u32 s43, s46, 18
    s_cmp_ge_u32 s46, 18
    s_cselect_b32 s46, s43, s46
    s_lshl_b32 s46, s46, 18
    s_add_u32 s46, s46, s52
    s_add_u32 m0, s53, 0
    s_nop 0
    buffer_load_dwordx4 v166, s[32:35], s46 offen lds
    v_lshrrev_b32 v2, 5, v1
    v_bfe_u32 v3, v1, 2, 2
    v_lshl_add_u32 v4, v2, 3, v3
    v_lshlrev_b32 v4, 9, v4
    v_bfe_u32 v2, v1, 4, 1
    v_bfe_u32 v5, v1, 1, 1
    v_lshl_add_u32 v2, v2, 1, v5
    v_lshl_add_u32 v4, v2, 4, v4
    v_and_b32 v5, 1, v1
    v_lshl_add_u32 v4, v5, 3, v4
    v_add_u32 v4, 32768, v4
    s_lshr_b32 s43, s72, 1
    s_lshl_b32 s43, s43, 2
    s_lshl_b32 s44, s73, 1
    s_add_u32 s43, s43, s44
    s_add_u32 s44, s43, 0
    v_xor_b32 v5, s44, v3
    v_lshl_add_u32 v6, v5, 6, v4
    s_add_u32 s44, s43, 1
    v_xor_b32 v5, s44, v3
    v_lshl_add_u32 v7, v5, 6, v4
    s_and_b32 s43, s72, 1
    s_lshl_b32 s44, s42, 1
    s_add_u32 s43, s43, s44
    s_lshl_b32 s43, s43, 18
    s_lshl_b32 s44, s41, 1
    s_lshr_b32 s45, s72, 1
    s_add_u32 s44, s44, s45
    s_lshl_b32 s44, s44, 13
    s_add_u32 s43, s43, s44
    v_lshlrev_b32 v2, 4, v1
    v_add_u32 v22, s43, v2
    v_mov_b32 v24, 0
    v_mov_b32 v25, 0
    v_mov_b32 v26, 0
    v_mov_b32 v27, 0
    v_mov_b32 v28, 0
    v_mov_b32 v29, 0
    v_mov_b32 v30, 0
    v_mov_b32 v31, 0
    v_mov_b32 v32, 0
    v_mov_b32 v33, 0
    v_mov_b32 v34, 0
    v_mov_b32 v35, 0
    v_mov_b32 v36, 0
    v_mov_b32 v37, 0
    v_mov_b32 v38, 0
    v_mov_b32 v39, 0
    v_mov_b32 v40, 0
    v_mov_b32 v41, 0
    v_mov_b32 v42, 0
    v_mov_b32 v43, 0
    v_mov_b32 v44, 0
    v_mov_b32 v45, 0
    v_mov_b32 v46, 0
    v_mov_b32 v47, 0
    v_mov_b32 v48, 0
    v_mov_b32 v49, 0
    v_mov_b32 v50, 0
    v_mov_b32 v51, 0
    v_mov_b32 v52, 0
    v_mov_b32 v53, 0
    v_mov_b32 v54, 0
    v_mov_b32 v55, 0
    v_add_u32 v8, 61440, v6
    v_add_u32 v9, 61440, v7
    s_mov_b32 s48, 0
    s_waitcnt vmcnt(4)
    s_barrier
    ds_read_b128 v[56:59], v88 offset:40960
    ds_read_b128 v[60:63], v89 offset:40960
    ds_read_b64_tr_b16 v[136:137], v6 offset:40960
    ds_read_b64_tr_b16 v[138:139], v6 offset:43008
    ds_read_b64_tr_b16 v[140:141], v7 offset:40960
    ds_read_b64_tr_b16 v[142:143], v7 offset:43008
    ds_read_b64_tr_b16 v[144:145], v6 offset:49152
    ds_read_b64_tr_b16 v[146:147], v6 offset:51200
    ds_read_b64_tr_b16 v[148:149], v7 offset:49152
    ds_read_b64_tr_b16 v[150:151], v7 offset:51200
    s_add_u32 s46, s42, 5
    s_sub_u32 s43, s46, 18
    s_cmp_ge_u32 s46, 18
    s_cselect_b32 s46, s43, s46
    s_lshl_b32 s46, s46, 18
    s_add_u32 s46, s46, s52
    s_add_u32 m0, s53, 20480
    s_nop 0
    buffer_load_dwordx4 v166, s[32:35], s46 offen lds
    s_waitcnt lgkmcnt(6)
    v_mfma_f32_32x32x16_bf16 v[24:39], v[136:139], v[56:59], v[24:39]
    s_waitcnt lgkmcnt(4)
    v_mfma_f32_32x32x16_bf16 v[40:55], v[140:143], v[56:59], v[40:55]
    s_waitcnt lgkmcnt(2)
    v_mfma_f32_32x32x16_bf16 v[24:39], v[144:147], v[60:63], v[24:39]
    s_waitcnt lgkmcnt(0)
    v_mfma_f32_32x32x16_bf16 v[40:55], v[148:151], v[60:63], v[40:55]
    s_waitcnt vmcnt(4)
    s_barrier
    ds_read_b128 v[64:67], v90 offset:0
    ds_read_b128 v[68:71], v91 offset:0
    ds_read_b64_tr_b16 v[136:137], v8 offset:0
    ds_read_b64_tr_b16 v[138:139], v8 offset:2048
    ds_read_b64_tr_b16 v[140:141], v9 offset:0
    ds_read_b64_tr_b16 v[142:143], v9 offset:2048
    ds_read_b64_tr_b16 v[144:145], v8 offset:8192
    ds_read_b64_tr_b16 v[146:147], v8 offset:10240
    ds_read_b64_tr_b16 v[148:149], v9 offset:8192
    ds_read_b64_tr_b16 v[150:151], v9 offset:10240
    s_add_u32 s46, s42, 6
    s_sub_u32 s43, s46, 18
    s_cmp_ge_u32 s46, 18
    s_cselect_b32 s46, s43, s46
    s_lshl_b32 s46, s46, 18
    s_add_u32 s46, s46, s52
    s_add_u32 m0, s53, 40960
    s_nop 0
    buffer_load_dwordx4 v166, s[32:35], s46 offen lds
    s_waitcnt lgkmcnt(6)
    v_mfma_f32_32x32x16_bf16 v[24:39], v[136:139], v[64:67], v[24:39]
    s_waitcnt lgkmcnt(4)
    v_mfma_f32_32x32x16_bf16 v[40:55], v[140:143], v[64:67], v[40:55]
    s_waitcnt lgkmcnt(2)
    v_mfma_f32_32x32x16_bf16 v[24:39], v[144:147], v[68:71], v[24:39]
    s_waitcnt lgkmcnt(0)
    v_mfma_f32_32x32x16_bf16 v[40:55], v[148:151], v[68:71], v[40:55]
    s_waitcnt vmcnt(4)
    s_barrier
    ds_read_b128 v[56:59], v90 offset:20480
    ds_read_b128 v[60:63], v91 offset:20480
    ds_read_b64_tr_b16 v[136:137], v8 offset:20480
    ds_read_b64_tr_b16 v[138:139], v8 offset:22528
    ds_read_b64_tr_b16 v[140:141], v9 offset:20480
    ds_read_b64_tr_b16 v[142:143], v9 offset:22528
    ds_read_b64_tr_b16 v[144:145], v8 offset:28672
    ds_read_b64_tr_b16 v[146:147], v8 offset:30720
    ds_read_b64_tr_b16 v[148:149], v9 offset:28672
    ds_read_b64_tr_b16 v[150:151], v9 offset:30720
    s_add_u32 s46, s42, 7
    s_sub_u32 s43, s46, 18
    s_cmp_ge_u32 s46, 18
    s_cselect_b32 s46, s43, s46
    s_lshl_b32 s46, s46, 18
    s_add_u32 s46, s46, s52
    s_add_u32 m0, s53, 61440
    s_nop 0
    buffer_load_dwordx4 v166, s[32:35], s46 offen lds
    s_waitcnt lgkmcnt(6)
    v_mfma_f32_32x32x16_bf16 v[24:39], v[136:139], v[56:59], v[24:39]
    s_waitcnt lgkmcnt(4)
    v_mfma_f32_32x32x16_bf16 v[40:55], v[140:143], v[56:59], v[40:55]
    s_waitcnt lgkmcnt(2)
    v_mfma_f32_32x32x16_bf16 v[24:39], v[144:147], v[60:63], v[24:39]
    s_waitcnt lgkmcnt(0)
    v_mfma_f32_32x32x16_bf16 v[40:55], v[148:151], v[60:63], v[40:55]
    s_waitcnt vmcnt(4)
    s_barrier
    ds_read_b128 v[64:67], v90 offset:40960
    ds_read_b128 v[68:71], v91 offset:40960
    ds_read_b64_tr_b16 v[136:137], v8 offset:40960
    ds_read_b64_tr_b16 v[138:139], v8 offset:43008
    ds_read_b64_tr_b16 v[140:141], v9 offset:40960
    ds_read_b64_tr_b16 v[142:143], v9 offset:43008
    ds_read_b64_tr_b16 v[144:145], v8 offset:49152
    ds_read_b64_tr_b16 v[146:147], v8 offset:51200
    ds_read_b64_tr_b16 v[148:149], v9 offset:49152
    ds_read_b64_tr_b16 v[150:151], v9 offset:51200
    s_add_u32 s46, s42, 8
    s_sub_u32 s43, s46, 18
    s_cmp_ge_u32 s46, 18
    s_cselect_b32 s46, s43, s46
    s_lshl_b32 s46, s46, 18
    s_add_u32 s46, s46, s52
    s_add_u32 m0, s53, 81920
    s_nop 0
    buffer_load_dwordx4 v166, s[32:35], s46 offen lds
    s_waitcnt lgkmcnt(6)
    v_mfma_f32_32x32x16_bf16 v[24:39], v[136:139], v[64:67], v[24:39]
    s_waitcnt lgkmcnt(4)
    v_mfma_f32_32x32x16_bf16 v[40:55], v[140:143], v[64:67], v[40:55]
    s_waitcnt lgkmcnt(2)
    v_mfma_f32_32x32x16_bf16 v[24:39], v[144:147], v[68:71], v[24:39]
    s_waitcnt lgkmcnt(0)
    v_mfma_f32_32x32x16_bf16 v[40:55], v[148:151], v[68:71], v[40:55]
    s_waitcnt vmcnt(4)
    s_barrier
    ds_read_b128 v[56:59], v88 offset:0
    ds_read_b128 v[60:63], v89 offset:0
    ds_read_b64_tr_b16 v[136:137], v6 offset:0
    ds_read_b64_tr_b16 v[138:139], v6 offset:2048
    ds_read_b64_tr_b16 v[140:141], v7 offset:0
    ds_read_b64_tr_b16 v[142:143], v7 offset:2048
    ds_read_b64_tr_b16 v[144:145], v6 offset:8192
    ds_read_b64_tr_b16 v[146:147], v6 offset:10240
    ds_read_b64_tr_b16 v[148:149], v7 offset:8192
    ds_read_b64_tr_b16 v[150:151], v7 offset:10240
    s_add_u32 s46, s42, 9
    s_sub_u32 s43, s46, 18
    s_cmp_ge_u32 s46, 18
    s_cselect_b32 s46, s43, s46
    s_lshl_b32 s46, s46, 18
    s_add_u32 s46, s46, s52
    s_add_u32 m0, s53, 102400
    s_nop 0
    buffer_load_dwordx4 v166, s[32:35], s46 offen lds
    s_waitcnt lgkmcnt(6)
    v_mfma_f32_32x32x16_bf16 v[24:39], v[136:139], v[56:59], v[24:39]
    s_waitcnt lgkmcnt(4)
    v_mfma_f32_32x32x16_bf16 v[40:55], v[140:143], v[56:59], v[40:55]
    s_waitcnt lgkmcnt(2)
    v_mfma_f32_32x32x16_bf16 v[24:39], v[144:147], v[60:63], v[24:39]
    s_waitcnt lgkmcnt(0)
    v_mfma_f32_32x32x16_bf16 v[40:55], v[148:151], v[60:63], v[40:55]
    s_waitcnt vmcnt(4)
    s_barrier
    ds_read_b128 v[64:67], v88 offset:20480
    ds_read_b128 v[68:71], v89 offset:20480
    ds_read_b64_tr_b16 v[136:137], v6 offset:20480
    ds_read_b64_tr_b16 v[138:139], v6 offset:22528
    ds_read_b64_tr_b16 v[140:141], v7 offset:20480
    ds_read_b64_tr_b16 v[142:143], v7 offset:22528
    ds_read_b64_tr_b16 v[144:145], v6 offset:28672
    ds_read_b64_tr_b16 v[146:147], v6 offset:30720
    ds_read_b64_tr_b16 v[148:149], v7 offset:28672
    ds_read_b64_tr_b16 v[150:151], v7 offset:30720
    s_add_u32 s46, s42, 10
    s_sub_u32 s43, s46, 18
    s_cmp_ge_u32 s46, 18
    s_cselect_b32 s46, s43, s46
    s_lshl_b32 s46, s46, 18
    s_add_u32 s46, s46, s52
    s_add_u32 m0, s53, 0
    s_nop 0
    buffer_load_dwordx4 v166, s[32:35], s46 offen lds
    s_waitcnt lgkmcnt(6)
    v_mfma_f32_32x32x16_bf16 v[24:39], v[136:139], v[64:67], v[24:39]
    s_waitcnt lgkmcnt(4)
    v_mfma_f32_32x32x16_bf16 v[40:55], v[140:143], v[64:67], v[40:55]
    s_waitcnt lgkmcnt(2)
    v_mfma_f32_32x32x16_bf16 v[24:39], v[144:147], v[68:71], v[24:39]
    s_waitcnt lgkmcnt(0)
    v_mfma_f32_32x32x16_bf16 v[40:55], v[148:151], v[68:71], v[40:55]
    s_waitcnt vmcnt(4)
    s_barrier
    ds_read_b128 v[56:59], v88 offset:40960
    ds_read_b128 v[60:63], v89 offset:40960
    ds_read_b64_tr_b16 v[136:137], v6 offset:40960
    ds_read_b64_tr_b16 v[138:139], v6 offset:43008
    ds_read_b64_tr_b16 v[140:141], v7 offset:40960
    ds_read_b64_tr_b16 v[142:143], v7 offset:43008
    ds_read_b64_tr_b16 v[144:145], v6 offset:49152
    ds_read_b64_tr_b16 v[146:147], v6 offset:51200
    ds_read_b64_tr_b16 v[148:149], v7 offset:49152
    ds_read_b64_tr_b16 v[150:151], v7 offset:51200
    s_add_u32 s46, s42, 11
    s_sub_u32 s43, s46, 18
    s_cmp_ge_u32 s46, 18
    s_cselect_b32 s46, s43, s46
    s_lshl_b32 s46, s46, 18
    s_add_u32 s46, s46, s52
    s_add_u32 m0, s53, 20480
    s_nop 0
    buffer_load_dwordx4 v166, s[32:35], s46 offen lds
    s_waitcnt lgkmcnt(6)
    v_mfma_f32_32x32x16_bf16 v[24:39], v[136:139], v[56:59], v[24:39]
    s_waitcnt lgkmcnt(4)
    v_mfma_f32_32x32x16_bf16 v[40:55], v[140:143], v[56:59], v[40:55]
    s_waitcnt lgkmcnt(2)
    v_mfma_f32_32x32x16_bf16 v[24:39], v[144:147], v[60:63], v[24:39]
    s_waitcnt lgkmcnt(0)
    v_mfma_f32_32x32x16_bf16 v[40:55], v[148:151], v[60:63], v[40:55]
    s_waitcnt vmcnt(4)
    s_barrier
    ds_read_b128 v[64:67], v90 offset:0
    ds_read_b128 v[68:71], v91 offset:0
    ds_read_b64_tr_b16 v[136:137], v8 offset:0
    ds_read_b64_tr_b16 v[138:139], v8 offset:2048
    ds_read_b64_tr_b16 v[140:141], v9 offset:0
    ds_read_b64_tr_b16 v[142:143], v9 offset:2048
    ds_read_b64_tr_b16 v[144:145], v8 offset:8192
    ds_read_b64_tr_b16 v[146:147], v8 offset:10240
    ds_read_b64_tr_b16 v[148:149], v9 offset:8192
    ds_read_b64_tr_b16 v[150:151], v9 offset:10240
    s_add_u32 s46, s42, 12
    s_sub_u32 s43, s46, 18
    s_cmp_ge_u32 s46, 18
    s_cselect_b32 s46, s43, s46
    s_lshl_b32 s46, s46, 18
    s_add_u32 s46, s46, s52
    s_add_u32 m0, s53, 40960
    s_nop 0
    buffer_load_dwordx4 v166, s[32:35], s46 offen lds
    s_waitcnt lgkmcnt(6)
    v_mfma_f32_32x32x16_bf16 v[24:39], v[136:139], v[64:67], v[24:39]
    s_waitcnt lgkmcnt(4)
    v_mfma_f32_32x32x16_bf16 v[40:55], v[140:143], v[64:67], v[40:55]
    s_waitcnt lgkmcnt(2)
    v_mfma_f32_32x32x16_bf16 v[24:39], v[144:147], v[68:71], v[24:39]
    s_waitcnt lgkmcnt(0)
    v_mfma_f32_32x32x16_bf16 v[40:55], v[148:151], v[68:71], v[40:55]
    s_mov_b32 s48, 8
    s_waitcnt vmcnt(4)
    s_barrier
    ds_read_b128 v[56:59], v90 offset:20480
    ds_read_b128 v[60:63], v91 offset:20480
    ds_read_b64_tr_b16 v[136:137], v8 offset:20480
    ds_read_b64_tr_b16 v[138:139], v8 offset:22528
    ds_read_b64_tr_b16 v[140:141], v9 offset:20480
    ds_read_b64_tr_b16 v[142:143], v9 offset:22528
    ds_read_b64_tr_b16 v[144:145], v8 offset:28672
    ds_read_b64_tr_b16 v[146:147], v8 offset:30720
    ds_read_b64_tr_b16 v[148:149], v9 offset:28672
    ds_read_b64_tr_b16 v[150:151], v9 offset:30720
    s_add_u32 s46, s42, 13
    s_sub_u32 s43, s46, 18
    s_cmp_ge_u32 s46, 18
    s_cselect_b32 s46, s43, s46
    s_lshl_b32 s46, s46, 18
    s_add_u32 s46, s46, s52
    s_add_u32 m0, s53, 61440
    s_nop 0
    buffer_load_dwordx4 v166, s[32:35], s46 offen lds
    s_waitcnt lgkmcnt(6)
    v_mfma_f32_32x32x16_bf16 v[24:39], v[136:139], v[56:59], v[24:39]
    s_waitcnt lgkmcnt(4)
    v_mfma_f32_32x32x16_bf16 v[40:55], v[140:143], v[56:59], v[40:55]
    s_waitcnt lgkmcnt(2)
    v_mfma_f32_32x32x16_bf16 v[24:39], v[144:147], v[60:63], v[24:39]
    s_waitcnt lgkmcnt(0)
    v_mfma_f32_32x32x16_bf16 v[40:55], v[148:151], v[60:63], v[40:55]
    s_waitcnt vmcnt(4)
    s_barrier
    ds_read_b128 v[64:67], v90 offset:40960
    ds_read_b128 v[68:71], v91 offset:40960
    ds_read_b64_tr_b16 v[136:137], v8 offset:40960
    ds_read_b64_tr_b16 v[138:139], v8 offset:43008
    ds_read_b64_tr_b16 v[140:141], v9 offset:40960
    ds_read_b64_tr_b16 v[142:143], v9 offset:43008
    ds_read_b64_tr_b16 v[144:145], v8 offset:49152
    ds_read_b64_tr_b16 v[146:147], v8 offset:51200
    ds_read_b64_tr_b16 v[148:149], v9 offset:49152
    ds_read_b64_tr_b16 v[150:151], v9 offset:51200
    s_add_u32 s46, s42, 14
    s_sub_u32 s43, s46, 18
    s_cmp_ge_u32 s46, 18
    s_cselect_b32 s46, s43, s46
    s_lshl_b32 s46, s46, 18
    s_add_u32 s46, s46, s52
    s_add_u32 m0, s53, 81920
    s_nop 0
    buffer_load_dwordx4 v166, s[32:35], s46 offen lds
    s_waitcnt lgkmcnt(6)
    v_mfma_f32_32x32x16_bf16 v[24:39], v[136:139], v[64:67], v[24:39]
    s_waitcnt lgkmcnt(4)
    v_mfma_f32_32x32x16_bf16 v[40:55], v[140:143], v[64:67], v[40:55]
    s_waitcnt lgkmcnt(2)
    v_mfma_f32_32x32x16_bf16 v[24:39], v[144:147], v[68:71], v[24:39]
    s_waitcnt lgkmcnt(0)
    v_mfma_f32_32x32x16_bf16 v[40:55], v[148:151], v[68:71], v[40:55]
    s_waitcnt vmcnt(4)
    s_barrier
    ds_read_b128 v[56:59], v88 offset:0
    ds_read_b128 v[60:63], v89 offset:0
    ds_read_b64_tr_b16 v[136:137], v6 offset:0
    ds_read_b64_tr_b16 v[138:139], v6 offset:2048
    ds_read_b64_tr_b16 v[140:141], v7 offset:0
    ds_read_b64_tr_b16 v[142:143], v7 offset:2048
    ds_read_b64_tr_b16 v[144:145], v6 offset:8192
    ds_read_b64_tr_b16 v[146:147], v6 offset:10240
    ds_read_b64_tr_b16 v[148:149], v7 offset:8192
    ds_read_b64_tr_b16 v[150:151], v7 offset:10240
    s_add_u32 s46, s42, 15
    s_sub_u32 s43, s46, 18
    s_cmp_ge_u32 s46, 18
    s_cselect_b32 s46, s43, s46
    s_lshl_b32 s46, s46, 18
    s_add_u32 s46, s46, s52
    s_add_u32 m0, s53, 102400
    s_nop 0
    buffer_load_dwordx4 v166, s[32:35], s46 offen lds
    s_waitcnt lgkmcnt(6)
    v_mfma_f32_32x32x16_bf16 v[24:39], v[136:139], v[56:59], v[24:39]
    s_waitcnt lgkmcnt(4)
    v_mfma_f32_32x32x16_bf16 v[40:55], v[140:143], v[56:59], v[40:55]
    s_waitcnt lgkmcnt(2)
    v_mfma_f32_32x32x16_bf16 v[24:39], v[144:147], v[60:63], v[24:39]
    s_waitcnt lgkmcnt(0)
    v_mfma_f32_32x32x16_bf16 v[40:55], v[148:151], v[60:63], v[40:55]
    s_waitcnt vmcnt(4)
    s_barrier
    ds_read_b128 v[64:67], v88 offset:20480
    ds_read_b128 v[68:71], v89 offset:20480
    ds_read_b64_tr_b16 v[136:137], v6 offset:20480
    ds_read_b64_tr_b16 v[138:139], v6 offset:22528
    ds_read_b64_tr_b16 v[140:141], v7 offset:20480
    ds_read_b64_tr_b16 v[142:143], v7 offset:22528
    ds_read_b64_tr_b16 v[144:145], v6 offset:28672
    ds_read_b64_tr_b16 v[146:147], v6 offset:30720
    ds_read_b64_tr_b16 v[148:149], v7 offset:28672
    ds_read_b64_tr_b16 v[150:151], v7 offset:30720
    s_add_u32 s46, s42, 16
    s_sub_u32 s43, s46, 18
    s_cmp_ge_u32 s46, 18
    s_cselect_b32 s46, s43, s46
    s_lshl_b32 s46, s46, 18
    s_add_u32 s46, s46, s52
    s_add_u32 m0, s53, 0
    s_nop 0
    buffer_load_dwordx4 v166, s[32:35], s46 offen lds
    s_waitcnt lgkmcnt(6)
    v_mfma_f32_32x32x16_bf16 v[24:39], v[136:139], v[64:67], v[24:39]
    s_waitcnt lgkmcnt(4)
    v_mfma_f32_32x32x16_bf16 v[40:55], v[140:143], v[64:67], v[40:55]
    s_waitcnt lgkmcnt(2)
    v_mfma_f32_32x32x16_bf16 v[24:39], v[144:147], v[68:71], v[24:39]
    s_waitcnt lgkmcnt(0)
    v_mfma_f32_32x32x16_bf16 v[40:55], v[148:151], v[68:71], v[40:55]
    s_waitcnt vmcnt(4)
    s_barrier
    ds_read_b128 v[56:59], v88 offset:40960
    ds_read_b128 v[60:63], v89 offset:40960
    ds_read_b64_tr_b16 v[136:137], v6 offset:40960
    ds_read_b64_tr_b16 v[138:139], v6 offset:43008
    ds_read_b64_tr_b16 v[140:141], v7 offset:40960
    ds_read_b64_tr_b16 v[142:143], v7 offset:43008
    ds_read_b64_tr_b16 v[144:145], v6 offset:49152
    ds_read_b64_tr_b16 v[146:147], v6 offset:51200
    ds_read_b64_tr_b16 v[148:149], v7 offset:49152
    ds_read_b64_tr_b16 v[150:151], v7 offset:51200
    s_add_u32 s46, s42, 17
    s_sub_u32 s43, s46, 18
    s_cmp_ge_u32 s46, 18
    s_cselect_b32 s46, s43, s46
    s_lshl_b32 s46, s46, 18
    s_add_u32 s46, s46, s52
    s_add_u32 m0, s53, 20480
    s_nop 0
    buffer_load_dwordx4 v166, s[32:35], s46 offen lds
    s_waitcnt lgkmcnt(6)
    v_mfma_f32_32x32x16_bf16 v[24:39], v[136:139], v[56:59], v[24:39]
    s_waitcnt lgkmcnt(4)
    v_mfma_f32_32x32x16_bf16 v[40:55], v[140:143], v[56:59], v[40:55]
    s_waitcnt lgkmcnt(2)
    v_mfma_f32_32x32x16_bf16 v[24:39], v[144:147], v[60:63], v[24:39]
    s_waitcnt lgkmcnt(0)
    v_mfma_f32_32x32x16_bf16 v[40:55], v[148:151], v[60:63], v[40:55]
    s_waitcnt vmcnt(4)
    s_barrier
    ds_read_b128 v[64:67], v90 offset:0
    ds_read_b128 v[68:71], v91 offset:0
    ds_read_b64_tr_b16 v[136:137], v8 offset:0
    ds_read_b64_tr_b16 v[138:139], v8 offset:2048
    ds_read_b64_tr_b16 v[140:141], v9 offset:0
    ds_read_b64_tr_b16 v[142:143], v9 offset:2048
    ds_read_b64_tr_b16 v[144:145], v8 offset:8192
    ds_read_b64_tr_b16 v[146:147], v8 offset:10240
    ds_read_b64_tr_b16 v[148:149], v9 offset:8192
    ds_read_b64_tr_b16 v[150:151], v9 offset:10240
    s_waitcnt lgkmcnt(6)
    v_mfma_f32_32x32x16_bf16 v[24:39], v[136:139], v[64:67], v[24:39]
    s_waitcnt lgkmcnt(4)
    v_mfma_f32_32x32x16_bf16 v[40:55], v[140:143], v[64:67], v[40:55]
    s_waitcnt lgkmcnt(2)
    v_mfma_f32_32x32x16_bf16 v[24:39], v[144:147], v[68:71], v[24:39]
    s_waitcnt lgkmcnt(0)
    v_mfma_f32_32x32x16_bf16 v[40:55], v[148:151], v[68:71], v[40:55]
    s_waitcnt vmcnt(3)
    s_barrier
    ds_read_b128 v[56:59], v90 offset:20480
    ds_read_b128 v[60:63], v91 offset:20480
    ds_read_b64_tr_b16 v[136:137], v8 offset:20480
    ds_read_b64_tr_b16 v[138:139], v8 offset:22528
    ds_read_b64_tr_b16 v[140:141], v9 offset:20480
    ds_read_b64_tr_b16 v[142:143], v9 offset:22528
    ds_read_b64_tr_b16 v[144:145], v8 offset:28672
    ds_read_b64_tr_b16 v[146:147], v8 offset:30720
    ds_read_b64_tr_b16 v[148:149], v9 offset:28672
    ds_read_b64_tr_b16 v[150:151], v9 offset:30720
    s_waitcnt lgkmcnt(6)
    v_mfma_f32_32x32x16_bf16 v[24:39], v[136:139], v[56:59], v[24:39]
    s_waitcnt lgkmcnt(4)
    v_mfma_f32_32x32x16_bf16 v[40:55], v[140:143], v[56:59], v[40:55]
    s_waitcnt lgkmcnt(2)
    v_mfma_f32_32x32x16_bf16 v[24:39], v[144:147], v[60:63], v[24:39]
    s_waitcnt lgkmcnt(0)
    v_mfma_f32_32x32x16_bf16 v[40:55], v[148:151], v[60:63], v[40:55]
    s_waitcnt vmcnt(2)
    s_barrier
    ds_read_b128 v[64:67], v90 offset:40960
    ds_read_b128 v[68:71], v91 offset:40960
    ds_read_b64_tr_b16 v[136:137], v8 offset:40960
    ds_read_b64_tr_b16 v[138:139], v8 offset:43008
    ds_read_b64_tr_b16 v[140:141], v9 offset:40960
    ds_read_b64_tr_b16 v[142:143], v9 offset:43008
    ds_read_b64_tr_b16 v[144:145], v8 offset:49152
    ds_read_b64_tr_b16 v[146:147], v8 offset:51200
    ds_read_b64_tr_b16 v[148:149], v9 offset:49152
    ds_read_b64_tr_b16 v[150:151], v9 offset:51200
    s_waitcnt lgkmcnt(6)
    v_mfma_f32_32x32x16_bf16 v[24:39], v[136:139], v[64:67], v[24:39]
    s_waitcnt lgkmcnt(4)
    v_mfma_f32_32x32x16_bf16 v[40:55], v[140:143], v[64:67], v[40:55]
    s_waitcnt lgkmcnt(2)
    v_mfma_f32_32x32x16_bf16 v[24:39], v[144:147], v[68:71], v[24:39]
    s_waitcnt lgkmcnt(0)
    v_mfma_f32_32x32x16_bf16 v[40:55], v[148:151], v[68:71], v[40:55]
    s_mov_b32 s48, 16
    s_waitcnt vmcnt(1)
    s_barrier
    ds_read_b128 v[56:59], v88 offset:0
    ds_read_b128 v[60:63], v89 offset:0
    ds_read_b64_tr_b16 v[136:137], v6 offset:0
    ds_read_b64_tr_b16 v[138:139], v6 offset:2048
    ds_read_b64_tr_b16 v[140:141], v7 offset:0
    ds_read_b64_tr_b16 v[142:143], v7 offset:2048
    ds_read_b64_tr_b16 v[144:145], v6 offset:8192
    ds_read_b64_tr_b16 v[146:147], v6 offset:10240
    ds_read_b64_tr_b16 v[148:149], v7 offset:8192
    ds_read_b64_tr_b16 v[150:151], v7 offset:10240
    s_waitcnt lgkmcnt(6)
    v_mfma_f32_32x32x16_bf16 v[24:39], v[136:139], v[56:59], v[24:39]
    s_waitcnt lgkmcnt(4)
    v_mfma_f32_32x32x16_bf16 v[40:55], v[140:143], v[56:59], v[40:55]
    s_waitcnt lgkmcnt(2)
    v_mfma_f32_32x32x16_bf16 v[24:39], v[144:147], v[60:63], v[24:39]
    s_waitcnt lgkmcnt(0)
    v_mfma_f32_32x32x16_bf16 v[40:55], v[148:151], v[60:63], v[40:55]
    s_waitcnt vmcnt(0)
    s_barrier
    ds_read_b128 v[64:67], v88 offset:20480
    ds_read_b128 v[68:71], v89 offset:20480
    ds_read_b64_tr_b16 v[136:137], v6 offset:20480
    ds_read_b64_tr_b16 v[138:139], v6 offset:22528
    ds_read_b64_tr_b16 v[140:141], v7 offset:20480
    ds_read_b64_tr_b16 v[142:143], v7 offset:22528
    ds_read_b64_tr_b16 v[144:145], v6 offset:28672
    ds_read_b64_tr_b16 v[146:147], v6 offset:30720
    ds_read_b64_tr_b16 v[148:149], v7 offset:28672
    ds_read_b64_tr_b16 v[150:151], v7 offset:30720
    s_waitcnt lgkmcnt(6)
    v_mfma_f32_32x32x16_bf16 v[24:39], v[136:139], v[64:67], v[24:39]
    s_waitcnt lgkmcnt(4)
    v_mfma_f32_32x32x16_bf16 v[40:55], v[140:143], v[64:67], v[40:55]
    s_waitcnt lgkmcnt(2)
    v_mfma_f32_32x32x16_bf16 v[24:39], v[144:147], v[68:71], v[24:39]
    s_waitcnt lgkmcnt(0)
    v_mfma_f32_32x32x16_bf16 v[40:55], v[148:151], v[68:71], v[40:55]
    s_nop 15
    s_lshl_b32 s43, s72, 13
    s_add_u32 s43, s43, 131072
    v_lshlrev_b32 v2, 4, v1
    v_add_u32 v2, s43, v2
    s_lshl_b32 s44, s73, 12
    v_add_u32 v3, s44, v2
    v_cvt_pk_bf16_f32 v136, v24, v25
    v_cvt_pk_bf16_f32 v137, v26, v27
    v_cvt_pk_bf16_f32 v138, v28, v29
    v_cvt_pk_bf16_f32 v139, v30, v31
    s_nop 1
    v_permlane32_swap_b32 v136, v138
    v_permlane32_swap_b32 v137, v139
    s_nop 1
    ds_write_b128 v3, v[136:139] offset:0
    v_cvt_pk_bf16_f32 v140, v32, v33
    v_cvt_pk_bf16_f32 v141, v34, v35
    v_cvt_pk_bf16_f32 v142, v36, v37
    v_cvt_pk_bf16_f32 v143, v38, v39
    s_nop 1
    v_permlane32_swap_b32 v140, v142
    v_permlane32_swap_b32 v141, v143
    s_nop 1
    ds_write_b128 v3, v[140:143] offset:1024
    v_cvt_pk_bf16_f32 v144, v40, v41
    v_cvt_pk_bf16_f32 v145, v42, v43
    v_cvt_pk_bf16_f32 v146, v44, v45
    v_cvt_pk_bf16_f32 v147, v46, v47
    s_nop 1
    v_permlane32_swap_b32 v144, v146
    v_permlane32_swap_b32 v145, v147
    s_nop 1
    ds_write_b128 v3, v[144:147] offset:2048
    v_cvt_pk_bf16_f32 v148, v48, v49
    v_cvt_pk_bf16_f32 v149, v50, v51
    v_cvt_pk_bf16_f32 v150, v52, v53
    v_cvt_pk_bf16_f32 v151, v54, v55
    s_nop 1
    v_permlane32_swap_b32 v148, v150
    v_permlane32_swap_b32 v149, v151
    s_nop 1
    ds_write_b128 v3, v[148:151] offset:3072
    s_waitcnt lgkmcnt(0)
    s_barrier
    ds_read_b128 v[104:107], v2 offset:0
    ds_read_b128 v[108:111], v2 offset:1024
    ds_read_b128 v[112:115], v2 offset:2048
    ds_read_b128 v[116:119], v2 offset:3072
    ds_read_b128 v[120:123], v2 offset:4096
    ds_read_b128 v[124:127], v2 offset:5120
    ds_read_b128 v[128:131], v2 offset:6144
    ds_read_b128 v[132:135], v2 offset:7168
    v_lshrrev_b32 v2, 5, v1
    v_and_b32 v3, 15, v1
    v_xor_b32 v2, v2, v3
    v_and_b32 v3, 31, v1
    v_lshlrev_b32 v3, 8, v3
    s_lshl_b32 s43, s73, 13
    v_add_u32 v3, s43, v3
    v_xor_b32 v4, 0, v2
    v_lshl_add_u32 v6, v4, 4, v3
    v_xor_b32 v4, 2, v2
    v_lshl_add_u32 v7, v4, 4, v3
    v_xor_b32 v4, 4, v2
    v_lshl_add_u32 v8, v4, 4, v3
    v_xor_b32 v4, 6, v2
    v_lshl_add_u32 v9, v4, 4, v3
    v_xor_b32 v4, 8, v2
    v_lshl_add_u32 v10, v4, 4, v3
    v_xor_b32 v4, 10, v2
    v_lshl_add_u32 v11, v4, 4, v3
    v_xor_b32 v4, 12, v2
    v_lshl_add_u32 v12, v4, 4, v3
    v_xor_b32 v4, 14, v2
    v_lshl_add_u32 v13, v4, 4, v3
    v_lshrrev_b32 v2, 5, v1
    v_bfe_u32 v3, v1, 2, 2
    v_lshl_add_u32 v4, v2, 2, v3
    v_lshlrev_b32 v4, 8, v4
    s_add_u32 s43, s43, 16384
    v_add_u32 v4, s43, v4
    v_bfe_u32 v2, v1, 4, 1
    v_bfe_u32 v5, v1, 1, 1
    v_lshl_add_u32 v2, v2, 1, v5
    v_lshl_add_u32 v4, v2, 4, v4
    v_and_b32 v5, 1, v1
    v_lshl_add_u32 v4, v5, 3, v4
    v_xor_b32 v5, 0, v3
    v_lshl_add_u32 v14, v5, 6, v4
    v_xor_b32 v5, 1, v3
    v_lshl_add_u32 v15, v5, 6, v4
    v_xor_b32 v5, 2, v3
    v_lshl_add_u32 v16, v5, 6, v4
    v_xor_b32 v5, 3, v3
    v_lshl_add_u32 v17, v5, 6, v4
    v_mov_b32 v18, 0xff800000
    v_mov_b32 v19, 0
    v_mov_b32 v24, 0
    v_mov_b32 v25, 0
    v_mov_b32 v26, 0
    v_mov_b32 v27, 0
    v_mov_b32 v28, 0
    v_mov_b32 v29, 0
    v_mov_b32 v30, 0
    v_mov_b32 v31, 0
    v_mov_b32 v32, 0
    v_mov_b32 v33, 0
    v_mov_b32 v34, 0
    v_mov_b32 v35, 0
    v_mov_b32 v36, 0
    v_mov_b32 v37, 0
    v_mov_b32 v38, 0
    v_mov_b32 v39, 0
    v_mov_b32 v40, 0
    v_mov_b32 v41, 0
    v_mov_b32 v42, 0
    v_mov_b32 v43, 0
    v_mov_b32 v44, 0
    v_mov_b32 v45, 0
    v_mov_b32 v46, 0
    v_mov_b32 v47, 0
    v_mov_b32 v48, 0
    v_mov_b32 v49, 0
    v_mov_b32 v50, 0
    v_mov_b32 v51, 0
    v_mov_b32 v52, 0
    v_mov_b32 v53, 0
    v_mov_b32 v54, 0
    v_mov_b32 v55, 0
    v_mov_b32 v56, 0
    v_mov_b32 v57, 0
    v_mov_b32 v58, 0
    v_mov_b32 v59, 0
    v_mov_b32 v60, 0
    v_mov_b32 v61, 0
    v_mov_b32 v62, 0
    v_mov_b32 v63, 0
    v_mov_b32 v64, 0
    v_mov_b32 v65, 0
    v_mov_b32 v66, 0
    v_mov_b32 v67, 0
    v_mov_b32 v68, 0
    v_mov_b32 v69, 0
    v_mov_b32 v70, 0
    v_mov_b32 v71, 0
    v_mov_b32 v72, 0
    v_mov_b32 v73, 0
    v_mov_b32 v74, 0
    v_mov_b32 v75, 0
    v_mov_b32 v76, 0
    v_mov_b32 v77, 0
    v_mov_b32 v78, 0
    v_mov_b32 v79, 0
    v_mov_b32 v80, 0
    v_mov_b32 v81, 0
    v_mov_b32 v82, 0
    v_mov_b32 v83, 0
    v_mov_b32 v84, 0
    v_mov_b32 v85, 0
    v_mov_b32 v86, 0
    v_mov_b32 v87, 0
    s_mov_b32 s47, 0x3e0293ee
    s_mov_b32 s48, 0
    s_mov_b32 s45, 0x1ffff
    s_waitcnt lgkmcnt(0)
attn_loop:
    s_barrier
    ds_read_b128 v[136:139], v6
    ds_read_b128 v[140:143], v7
    ds_read_b128 v[144:147], v8
    ds_read_b128 v[148:151], v9
    ds_read_b128 v[152:155], v10
    ds_read_b128 v[156:159], v11
    s_waitcnt lgkmcnt(5)
    v_mfma_f32_32x32x16_bf16 v[88:103], v[136:139], v[104:107], 0
    ds_read_b128 v[136:139], v12
    s_waitcnt lgkmcnt(5)
    v_mfma_f32_32x32x16_bf16 v[88:103], v[140:143], v[108:111], v[88:103]
    ds_read_b128 v[140:143], v13
    s_waitcnt lgkmcnt(5)
    v_mfma_f32_32x32x16_bf16 v[88:103], v[144:147], v[112:115], v[88:103]
    ds_read_b64_tr_b16 v[144:145], v14 offset:0
    ds_read_b64_tr_b16 v[146:147], v14 offset:2048
    s_waitcnt lgkmcnt(6)
    v_mfma_f32_32x32x16_bf16 v[88:103], v[148:151], v[116:119], v[88:103]
    ds_read_b64_tr_b16 v[148:149], v15 offset:0
    ds_read_b64_tr_b16 v[150:151], v15 offset:2048
    s_waitcnt lgkmcnt(7)
    v_mfma_f32_32x32x16_bf16 v[88:103], v[152:155], v[120:123], v[88:103]
    ds_read_b64_tr_b16 v[152:153], v16 offset:0
    ds_read_b64_tr_b16 v[154:155], v16 offset:2048
    s_waitcnt lgkmcnt(8)
    v_mfma_f32_32x32x16_bf16 v[88:103], v[156:159], v[124:127], v[88:103]
    ds_read_b64_tr_b16 v[156:157], v17 offset:0
    ds_read_b64_tr_b16 v[158:159], v17 offset:2048
    s_waitcnt lgkmcnt(9)
    v_mfma_f32_32x32x16_bf16 v[88:103], v[136:139], v[128:131], v[88:103]
    ds_read_b64_tr_b16 v[136:137], v14 offset:4096
    ds_read_b64_tr_b16 v[138:139], v14 offset:6144
    s_waitcnt lgkmcnt(10)
    v_mfma_f32_32x32x16_bf16 v[88:103], v[140:143], v[132:135], v[88:103]
    ds_read_b64_tr_b16 v[140:141], v15 offset:4096
    ds_read_b64_tr_b16 v[142:143], v15 offset:6144
    v_add_u32 v6, 0x8000, v6
    v_and_b32 v6, s45, v6
    v_add_u32 v7, 0x8000, v7
    v_and_b32 v7, s45, v7
    v_add_u32 v8, 0x8000, v8
    v_and_b32 v8, s45, v8
    v_add_u32 v9, 0x8000, v9
    v_and_b32 v9, s45, v9
    v_add_u32 v10, 0x8000, v10
    v_and_b32 v10, s45, v10
    v_add_u32 v11, 0x8000, v11
    v_and_b32 v11, s45, v11
    v_add_u32 v12, 0x8000, v12
    v_and_b32 v12, s45, v12
    v_add_u32 v13, 0x8000, v13
    v_and_b32 v13, s45, v13
    v_max3_f32 v2, v88, v89, v90
    v_max3_f32 v3, v91, v92, v93
    v_max3_f32 v2, v2, v94, v95
    v_max3_f32 v3, v3, v96, v97
    v_max3_f32 v2, v2, v98, v99
    v_max3_f32 v3, v3, v100, v101
    v_max3_f32 v2, v2, v102, v103
    v_max_f32 v2, v2, v3
    v_mov_b32 v3, v2
    s_nop 1
    v_permlane32_swap_b32 v2, v3
    s_nop 1
    v_max3_f32 v2, v2, v3, v18
    v_cmp_neq_f32 vcc, v2, v18
    v_sub_f32 v3, v18, v2
    v_mul_f32 v3, s47, v3
    v_exp_f32 v20, v3
    v_mov_b32 v18, v2
    v_mul_f32 v2, s47, v2
    v_mov_b32 v21, v20
    v_fma_f32 v88, v88, s47, -v2
    v_fma_f32 v89, v89, s47, -v2
    v_fma_f32 v90, v90, s47, -v2
    v_fma_f32 v91, v91, s47, -v2
    v_fma_f32 v92, v92, s47, -v2
    v_fma_f32 v93, v93, s47, -v2
    v_fma_f32 v94, v94, s47, -v2
    v_fma_f32 v95, v95, s47, -v2
    v_fma_f32 v96, v96, s47, -v2
    v_fma_f32 v97, v97, s47, -v2
    v_fma_f32 v98, v98, s47, -v2
    v_fma_f32 v99, v99, s47, -v2
    v_fma_f32 v100, v100, s47, -v2
    v_fma_f32 v101, v101, s47, -v2
    v_fma_f32 v102, v102, s47, -v2
    v_fma_f32 v103, v103, s47, -v2
    v_exp_f32 v88, v88
    v_exp_f32 v89, v89
    v_exp_f32 v90, v90
    v_exp_f32 v91, v91
    v_exp_f32 v92, v92
    v_exp_f32 v93, v93
    v_exp_f32 v94, v94
    v_exp_f32 v95, v95
    v_exp_f32 v96, v96
    v_exp_f32 v97, v97
    v_exp_f32 v98, v98
    v_exp_f32 v99, v99
    v_exp_f32 v100, v100
    v_exp_f32 v101, v101
    v_exp_f32 v102, v102
    v_exp_f32 v103, v103
    s_cbranch_vccz attn_noresc
    v_mul_f32 v19, v19, v20
    v_pk_mul_f32 v[24:25], v[24:25], v[20:21]
    v_pk_mul_f32 v[26:27], v[26:27], v[20:21]
    v_pk_mul_f32 v[28:29], v[28:29], v[20:21]
    v_pk_mul_f32 v[30:31], v[30:31], v[20:21]
    v_pk_mul_f32 v[32:33], v[32:33], v[20:21]
    v_pk_mul_f32 v[34:35], v[34:35], v[20:21]
    v_pk_mul_f32 v[36:37], v[36:37], v[20:21]
    v_pk_mul_f32 v[38:39], v[38:39], v[20:21]
    v_pk_mul_f32 v[40:41], v[40:41], v[20:21]
    v_pk_mul_f32 v[42:43], v[42:43], v[20:21]
    v_pk_mul_f32 v[44:45], v[44:45], v[20:21]
    v_pk_mul_f32 v[46:47], v[46:47], v[20:21]
    v_pk_mul_f32 v[48:49], v[48:49], v[20:21]
    v_pk_mul_f32 v[50:51], v[50:51], v[20:21]
    v_pk_mul_f32 v[52:53], v[52:53], v[20:21]
    v_pk_mul_f32 v[54:55], v[54:55], v[20:21]
    v_pk_mul_f32 v[56:57], v[56:57], v[20:21]
    v_pk_mul_f32 v[58:59], v[58:59], v[20:21]
    v_pk_mul_f32 v[60:61], v[60:61], v[20:21]
    v_pk_mul_f32 v[62:63], v[62:63], v[20:21]
    v_pk_mul_f32 v[64:65], v[64:65], v[20:21]
    v_pk_mul_f32 v[66:67], v[66:67], v[20:21]
    v_pk_mul_f32 v[68:69], v[68:69], v[20:21]
    v_pk_mul_f32 v[70:71], v[70:71], v[20:21]
    v_pk_mul_f32 v[72:73], v[72:73], v[20:21]
    v_pk_mul_f32 v[74:75], v[74:75], v[20:21]
    v_pk_mul_f32 v[76:77], v[76:77], v[20:21]
    v_pk_mul_f32 v[78:79], v[78:79], v[20:21]
    v_pk_mul_f32 v[80:81], v[80:81], v[20:21]
    v_pk_mul_f32 v[82:83], v[82:83], v[20:21]
    v_pk_mul_f32 v[84:85], v[84:85], v[20:21]
    v_pk_mul_f32 v[86:87], v[86:87], v[20:21]
attn_noresc:
    v_add_f32 v3, v88, v89
    v_add_f32 v4, v90, v91
    v_add_f32 v3, v3, v92
    v_add_f32 v3, v3, v93
    v_add_f32 v4, v4, v94
    v_add_f32 v4, v4, v95
    v_add_f32 v3, v3, v96
    v_add_f32 v3, v3, v97
    v_add_f32 v4, v4, v98
    v_add_f32 v4, v4, v99
    v_add_f32 v3, v3, v100
    v_add_f32 v3, v3, v101
    v_add_f32 v4, v4, v102
    v_add_f32 v4, v4, v103
    v_add_f32 v3, v3, v4
    v_add_f32 v19, v19, v3
    v_cvt_pk_bf16_f32 v160, v88, v89
    v_cvt_pk_bf16_f32 v161, v90, v91
    v_cvt_pk_bf16_f32 v162, v92, v93
    v_cvt_pk_bf16_f32 v163, v94, v95
    v_cvt_pk_bf16_f32 v164, v96, v97
    v_cvt_pk_bf16_f32 v165, v98, v99
    v_cvt_pk_bf16_f32 v166, v100, v101
    v_cvt_pk_bf16_f32 v167, v102, v103
    s_nop 1
    s_waitcnt lgkmcnt(10)
    v_mfma_f32_32x32x16_bf16 v[24:39], v[144:147], v[160:163], v[24:39]
    ds_read_b64_tr_b16 v[144:145], v16 offset:4096
    ds_read_b64_tr_b16 v[146:147], v16 offset:6144
    s_waitcnt lgkmcnt(10)
    v_mfma_f32_32x32x16_bf16 v[40:55], v[148:151], v[160:163], v[40:55]
    ds_read_b64_tr_b16 v[148:149], v17 offset:4096
    ds_read_b64_tr_b16 v[150:151], v17 offset:6144
    s_waitcnt lgkmcnt(10)
    v_mfma_f32_32x32x16_bf16 v[56:71], v[152:155], v[160:163], v[56:71]
    s_waitcnt lgkmcnt(8)
    v_mfma_f32_32x32x16_bf16 v[72:87], v[156:159], v[160:163], v[72:87]
    s_waitcnt lgkmcnt(6)
    v_mfma_f32_32x32x16_bf16 v[24:39], v[136:139], v[164:167], v[24:39]
    s_waitcnt lgkmcnt(4)
    v_mfma_f32_32x32x16_bf16 v[40:55], v[140:143], v[164:167], v[40:55]
    s_waitcnt lgkmcnt(2)
    v_mfma_f32_32x32x16_bf16 v[56:71], v[144:147], v[164:167], v[56:71]
    s_waitcnt lgkmcnt(0)
    v_mfma_f32_32x32x16_bf16 v[72:87], v[148:151], v[164:167], v[72:87]
    v_add_u32 v14, 0x8000, v14
    v_and_b32 v14, s45, v14
    v_add_u32 v15, 0x8000, v15
    v_and_b32 v15, s45, v15
    v_add_u32 v16, 0x8000, v16
    v_and_b32 v16, s45, v16
    v_add_u32 v17, 0x8000, v17
    v_and_b32 v17, s45, v17
    s_add_u32 s48, s48, 1
    s_cmp_lt_u32 s48, 16
    s_cbranch_scc1 attn_loop
    s_nop 15
    v_mov_b32 v2, v19
    v_mov_b32 v3, v19
    s_nop 1
    v_permlane32_swap_b32 v2, v3
    s_nop 1
    v_add_f32 v19, v2, v3
    s_barrier
    s_lshl_b32 s43, s72, 1
    s_add_u32 s44, s43, s73
    s_xor_b32 s43, s44, 1
    s_mul_i32 s44, s44, 8704
    s_mul_i32 s43, s43, 8704
    v_lshlrev_b32 v2, 4, v1
    v_lshlrev_b32 v3, 3, v1
    v_add_u32 v4, s44, v2
    v_add_u32 v5, s44, v3
    v_add_u32 v2, s43, v2
    v_add_u32 v3, s43, v3
    ds_write_b64 v5, v[18:19] offset:8192
    s_cmp_eq_u32 s73, 0
    s_cbranch_scc1 attn_merge0
    ds_write_b128 v4, v[24:27] offset:0
    ds_write_b128 v4, v[28:31] offset:1024
    ds_write_b128 v4, v[32:35] offset:2048
    ds_write_b128 v4, v[36:39] offset:3072
    ds_write_b128 v4, v[40:43] offset:4096
    ds_write_b128 v4, v[44:47] offset:5120
    ds_write_b128 v4, v[48:51] offset:6144
    ds_write_b128 v4, v[52:55] offset:7168
    s_waitcnt lgkmcnt(0)
    s_barrier
    ds_read_b64 v[160:161], v3 offset:8192
    ds_read_b128 v[104:107], v2 offset:0
    ds_read_b128 v[108:111], v2 offset:1024
    ds_read_b128 v[112:115], v2 offset:2048
    ds_read_b128 v[116:119], v2 offset:3072
    ds_read_b128 v[120:123], v2 offset:4096
    ds_read_b128 v[124:127], v2 offset:5120
    ds_read_b128 v[128:131], v2 offset:6144
    ds_read_b128 v[132:135], v2 offset:7168
    s_waitcnt lgkmcnt(8)
    v_max_f32 v4, v18, v160
    v_sub_f32 v5, v18, v4
    v_mul_f32 v5, s47, v5
    v_exp_f32 v20, v5
    v_sub_f32 v5, v160, v4
    v_mul_f32 v5, s47, v5
    v_exp_f32 v162, v5
    s_nop 0
    v_mul_f32 v19, v19, v20
    v_fma_f32 v19, v161, v162, v19
    v_rcp_f32 v5, v19
    s_nop 0
    v_mul_f32 v20, v20, v5
    v_mul_f32 v162, v162, v5
    v_mov_b32 v21, v20
    v_mov_b32 v163, v162
    s_movk_i32 s43, 4096
    s_waitcnt lgkmcnt(0)
    v_pk_mul_f32 v[56:57], v[56:57], v[20:21]
    v_pk_fma_f32 v[56:57], v[104:105], v[162:163], v[56:57]
    v_pk_mul_f32 v[58:59], v[58:59], v[20:21]
    v_pk_fma_f32 v[58:59], v[106:107], v[162:163], v[58:59]
    v_pk_mul_f32 v[60:61], v[60:61], v[20:21]
    v_pk_fma_f32 v[60:61], v[108:109], v[162:163], v[60:61]
    v_pk_mul_f32 v[62:63], v[62:63], v[20:21]
    v_pk_fma_f32 v[62:63], v[110:111], v[162:163], v[62:63]
    v_pk_mul_f32 v[64:65], v[64:65], v[20:21]
    v_pk_fma_f32 v[64:65], v[112:113], v[162:163], v[64:65]
    v_pk_mul_f32 v[66:67], v[66:67], v[20:21]
    v_pk_fma_f32 v[66:67], v[114:115], v[162:163], v[66:67]
    v_pk_mul_f32 v[68:69], v[68:69], v[20:21]
    v_pk_fma_f32 v[68:69], v[116:117], v[162:163], v[68:69]
    v_pk_mul_f32 v[70:71], v[70:71], v[20:21]
    v_pk_fma_f32 v[70:71], v[118:119], v[162:163], v[70:71]
    v_pk_mul_f32 v[72:73], v[72:73], v[20:21]
    v_pk_fma_f32 v[72:73], v[120:121], v[162:163], v[72:73]
    v_pk_mul_f32 v[74:75], v[74:75], v[20:21]
    v_pk_fma_f32 v[74:75], v[122:123], v[162:163], v[74:75]
    v_pk_mul_f32 v[76:77], v[76:77], v[20:21]
    v_pk_fma_f32 v[76:77], v[124:125], v[162:163], v[76:77]
    v_pk_mul_f32 v[78:79], v[78:79], v[20:21]
    v_pk_fma_f32 v[78:79], v[126:127], v[162:163], v[78:79]
    v_pk_mul_f32 v[80:81], v[80:81], v[20:21]
    v_pk_fma_f32 v[80:81], v[128:129], v[162:163], v[80:81]
    v_pk_mul_f32 v[82:83], v[82:83], v[20:21]
    v_pk_fma_f32 v[82:83], v[130:131], v[162:163], v[82:83]
    v_pk_mul_f32 v[84:85], v[84:85], v[20:21]
    v_pk_fma_f32 v[84:85], v[132:133], v[162:163], v[84:85]
    v_pk_mul_f32 v[86:87], v[86:87], v[20:21]
    v_pk_fma_f32 v[86:87], v[134:135], v[162:163], v[86:87]
    v_cvt_pk_bf16_f32 v152, v56, v57
    v_cvt_pk_bf16_f32 v153, v58, v59
    v_cvt_pk_bf16_f32 v154, v60, v61
    v_cvt_pk_bf16_f32 v155, v62, v63
    s_nop 1
    v_permlane32_swap_b32 v152, v154
    v_permlane32_swap_b32 v153, v155
    s_nop 1
    buffer_store_dwordx4 v[152:155], v22, s[36:39], s43 offen offset:0 sc0 sc1
    v_cvt_pk_bf16_f32 v156, v64, v65
    v_cvt_pk_bf16_f32 v157, v66, v67
    v_cvt_pk_bf16_f32 v158, v68, v69
    v_cvt_pk_bf16_f32 v159, v70, v71
    s_nop 1
    v_permlane32_swap_b32 v156, v158
    v_permlane32_swap_b32 v157, v159
    s_nop 1
    buffer_store_dwordx4 v[156:159], v22, s[36:39], s43 offen offset:1024 sc0 sc1
    v_cvt_pk_bf16_f32 v136, v72, v73
    v_cvt_pk_bf16_f32 v137, v74, v75
    v_cvt_pk_bf16_f32 v138, v76, v77
    v_cvt_pk_bf16_f32 v139, v78, v79
    s_nop 1
    v_permlane32_swap_b32 v136, v138
    v_permlane32_swap_b32 v137, v139
    s_nop 1
    buffer_store_dwordx4 v[136:139], v22, s[36:39], s43 offen offset:2048 sc0 sc1
    v_cvt_pk_bf16_f32 v140, v80, v81
    v_cvt_pk_bf16_f32 v141, v82, v83
    v_cvt_pk_bf16_f32 v142, v84, v85
    v_cvt_pk_bf16_f32 v143, v86, v87
    s_nop 1
    v_permlane32_swap_b32 v140, v142
    v_permlane32_swap_b32 v141, v143
    s_nop 1
    buffer_store_dwordx4 v[140:143], v22, s[36:39], s43 offen offset:3072 sc0 sc1
    s_endpgm
attn_merge0:
    ds_write_b128 v4, v[56:59] offset:0
    ds_write_b128 v4, v[60:63] offset:1024
    ds_write_b128 v4, v[64:67] offset:2048
    ds_write_b128 v4, v[68:71] offset:3072
    ds_write_b128 v4, v[72:75] offset:4096
    ds_write_b128 v4, v[76:79] offset:5120
    ds_write_b128 v4, v[80:83] offset:6144
    ds_write_b128 v4, v[84:87] offset:7168
    s_waitcnt lgkmcnt(0)
    s_barrier
    ds_read_b64 v[160:161], v3 offset:8192
    ds_read_b128 v[104:107], v2 offset:0
    ds_read_b128 v[108:111], v2 offset:1024
    ds_read_b128 v[112:115], v2 offset:2048
    ds_read_b128 v[116:119], v2 offset:3072
    ds_read_b128 v[120:123], v2 offset:4096
    ds_read_b128 v[124:127], v2 offset:5120
    ds_read_b128 v[128:131], v2 offset:6144
    ds_read_b128 v[132:135], v2 offset:7168
    s_waitcnt lgkmcnt(8)
    v_max_f32 v4, v18, v160
    v_sub_f32 v5, v18, v4
    v_mul_f32 v5, s47, v5
    v_exp_f32 v20, v5
    v_sub_f32 v5, v160, v4
    v_mul_f32 v5, s47, v5
    v_exp_f32 v162, v5
    s_nop 0
    v_mul_f32 v19, v19, v20
    v_fma_f32 v19, v161, v162, v19
    v_rcp_f32 v5, v19
    s_nop 0
    v_mul_f32 v20, v20, v5
    v_mul_f32 v162, v162, v5
    v_mov_b32 v21, v20
    v_mov_b32 v163, v162
    s_movk_i32 s43, 0
    s_waitcnt lgkmcnt(0)
    v_pk_mul_f32 v[24:25], v[24:25], v[20:21]
    v_pk_fma_f32 v[24:25], v[104:105], v[162:163], v[24:25]
    v_pk_mul_f32 v[26:27], v[26:27], v[20:21]
    v_pk_fma_f32 v[26:27], v[106:107], v[162:163], v[26:27]
    v_pk_mul_f32 v[28:29], v[28:29], v[20:21]
    v_pk_fma_f32 v[28:29], v[108:109], v[162:163], v[28:29]
    v_pk_mul_f32 v[30:31], v[30:31], v[20:21]
    v_pk_fma_f32 v[30:31], v[110:111], v[162:163], v[30:31]
    v_pk_mul_f32 v[32:33], v[32:33], v[20:21]
    v_pk_fma_f32 v[32:33], v[112:113], v[162:163], v[32:33]
    v_pk_mul_f32 v[34:35], v[34:35], v[20:21]
    v_pk_fma_f32 v[34:35], v[114:115], v[162:163], v[34:35]
    v_pk_mul_f32 v[36:37], v[36:37], v[20:21]
    v_pk_fma_f32 v[36:37], v[116:117], v[162:163], v[36:37]
    v_pk_mul_f32 v[38:39], v[38:39], v[20:21]
    v_pk_fma_f32 v[38:39], v[118:119], v[162:163], v[38:39]
    v_pk_mul_f32 v[40:41], v[40:41], v[20:21]
    v_pk_fma_f32 v[40:41], v[120:121], v[162:163], v[40:41]
    v_pk_mul_f32 v[42:43], v[42:43], v[20:21]
    v_pk_fma_f32 v[42:43], v[122:123], v[162:163], v[42:43]
    v_pk_mul_f32 v[44:45], v[44:45], v[20:21]
    v_pk_fma_f32 v[44:45], v[124:125], v[162:163], v[44:45]
    v_pk_mul_f32 v[46:47], v[46:47], v[20:21]
    v_pk_fma_f32 v[46:47], v[126:127], v[162:163], v[46:47]
    v_pk_mul_f32 v[48:49], v[48:49], v[20:21]
    v_pk_fma_f32 v[48:49], v[128:129], v[162:163], v[48:49]
    v_pk_mul_f32 v[50:51], v[50:51], v[20:21]
    v_pk_fma_f32 v[50:51], v[130:131], v[162:163], v[50:51]
    v_pk_mul_f32 v[52:53], v[52:53], v[20:21]
    v_pk_fma_f32 v[52:53], v[132:133], v[162:163], v[52:53]
    v_pk_mul_f32 v[54:55], v[54:55], v[20:21]
    v_pk_fma_f32 v[54:55], v[134:135], v[162:163], v[54:55]
    v_cvt_pk_bf16_f32 v136, v24, v25
    v_cvt_pk_bf16_f32 v137, v26, v27
    v_cvt_pk_bf16_f32 v138, v28, v29
    v_cvt_pk_bf16_f32 v139, v30, v31
    s_nop 1
    v_permlane32_swap_b32 v136, v138
    v_permlane32_swap_b32 v137, v139
    s_nop 1
    buffer_store_dwordx4 v[136:139], v22, s[36:39], s43 offen offset:0 sc0 sc1
    v_cvt_pk_bf16_f32 v140, v32, v33
    v_cvt_pk_bf16_f32 v141, v34, v35
    v_cvt_pk_bf16_f32 v142, v36, v37
    v_cvt_pk_bf16_f32 v143, v38, v39
    s_nop 1
    v_permlane32_swap_b32 v140, v142
    v_permlane32_swap_b32 v141, v143
    s_nop 1
    buffer_store_dwordx4 v[140:143], v22, s[36:39], s43 offen offset:1024 sc0 sc1
    v_cvt_pk_bf16_f32 v144, v40, v41
    v_cvt_pk_bf16_f32 v145, v42, v43
    v_cvt_pk_bf16_f32 v146, v44, v45
    v_cvt_pk_bf16_f32 v147, v46, v47
    s_nop 1
    v_permlane32_swap_b32 v144, v146
    v_permlane32_swap_b32 v145, v147
    s_nop 1
    buffer_store_dwordx4 v[144:147], v22, s[36:39], s43 offen offset:2048 sc0 sc1
    v_cvt_pk_bf16_f32 v148, v48, v49
    v_cvt_pk_bf16_f32 v149, v50, v51
    v_cvt_pk_bf16_f32 v150, v52, v53
    v_cvt_pk_bf16_f32 v151, v54, v55
    s_nop 1
    v_permlane32_swap_b32 v148, v150
    v_permlane32_swap_b32 v149, v151
    s_nop 1
    buffer_store_dwordx4 v[148:151], v22, s[36:39], s43 offen offset:3072 sc0 sc1
    s_endpgm
attn_loader:
    s_sub_u32 s44, s40, 8
    s_lshl_b32 s54, s44, 12
    s_lshl_b32 s52, s44, 15
    s_lshl_b32 s53, s44, 11
    s_add_u32 s53, s53, 32768
    s_lshl_b32 s43, s42, 4
    s_add_u32 s43, s43, s41
    s_lshl_b32 s43, s43, 18
    s_add_u32 s20, s6, s43
    s_addc_u32 s21, s7, 0
    s_mov_b32 s22, 0x40000
    s_mov_b32 s23, 0x20000
    s_add_u32 s24, s8, s43
    s_addc_u32 s25, s9, 0
    s_mov_b32 s26, 0x40000
    s_mov_b32 s27, 0x20000
    s_mul_i32 s43, s42, 73728
    s_add_u32 s28, s4, s43
    s_addc_u32 s29, s5, 0
    s_mov_b32 s30, 73728
    s_mov_b32 s31, 0x20000
    s_lshl_b32 s55, s44, 10
    s_add_u32 s55, s55, 49152
    s_lshl_b32 s43, s44, 4
    v_lshrrev_b32 v2, 2, v1
    v_add_u32 v2, s43, v2
    s_movk_i32 s43, 1152
    v_mul_lo_u32 v2, v2, s43
    v_and_b32 v3, 3, v1
    v_bfe_u32 v4, v1, 4, 2
    v_xor_b32 v3, v3, v4
    v_lshl_add_u32 v11, v3, 4, v2
    s_add_u32 s51, s42, 0
    s_sub_u32 s43, s51, 18
    s_cmp_ge_u32 s51, 18
    s_cselect_b32 s51, s43, s51
    s_lshl_b32 s51, s51, 6
    s_add_u32 m0, s55, 40960
    s_nop 0
    buffer_load_dwordx4 v11, s[28:31], s51 offen lds
    s_add_u32 s46, s42, 0
    s_sub_u32 s43, s46, 18
    s_cmp_ge_u32 s46, 18
    s_cselect_b32 s46, s43, s46
    s_lshl_b32 s46, s46, 18
    s_add_u32 s46, s46, s52
    s_add_u32 m0, s53, 40960
    s_nop 0
    buffer_load_dwordx4 v166, s[32:35], s46 offen lds
    s_add_u32 s46, s46, 15360
    buffer_load_dwordx4 v167, s[32:35], s46 offen offset:1024 lds
    s_add_u32 s51, s42, 1
    s_sub_u32 s43, s51, 18
    s_cmp_ge_u32 s51, 18
    s_cselect_b32 s51, s43, s51
    s_lshl_b32 s51, s51, 6
    s_add_u32 m0, s55, 61440
    s_nop 0
    buffer_load_dwordx4 v11, s[28:31], s51 offen lds
    s_add_u32 s46, s42, 1
    s_sub_u32 s43, s46, 18
    s_cmp_ge_u32 s46, 18
    s_cselect_b32 s46, s43, s46
    s_lshl_b32 s46, s46, 18
    s_add_u32 s46, s46, s52
    s_add_u32 m0, s53, 61440
    s_nop 0
    buffer_load_dwordx4 v166, s[32:35], s46 offen lds
    s_add_u32 s46, s46, 15360
    buffer_load_dwordx4 v167, s[32:35], s46 offen offset:1024 lds
    s_add_u32 s51, s42, 2
    s_sub_u32 s43, s51, 18
    s_cmp_ge_u32 s51, 18
    s_cselect_b32 s51, s43, s51
    s_lshl_b32 s51, s51, 6
    s_add_u32 m0, s55, 81920
    s_nop 0
    buffer_load_dwordx4 v11, s[28:31], s51 offen lds
    s_add_u32 s46, s42, 2
    s_sub_u32 s43, s46, 18
    s_cmp_ge_u32 s46, 18
    s_cselect_b32 s46, s43, s46
    s_lshl_b32 s46, s46, 18
    s_add_u32 s46, s46, s52
    s_add_u32 m0, s53, 81920
    s_nop 0
    buffer_load_dwordx4 v166, s[32:35], s46 offen lds
    s_add_u32 s46, s46, 15360
    buffer_load_dwordx4 v167, s[32:35], s46 offen offset:1024 lds
    s_add_u32 s51, s42, 3
    s_sub_u32 s43, s51, 18
    s_cmp_ge_u32 s51, 18
    s_cselect_b32 s51, s43, s51
    s_lshl_b32 s51, s51, 6
    s_add_u32 m0, s55, 102400
    s_nop 0
    buffer_load_dwordx4 v11, s[28:31], s51 offen lds
    s_add_u32 s46, s42, 3
    s_sub_u32 s43, s46, 18
    s_cmp_ge_u32 s46, 18
    s_cselect_b32 s46, s43, s46
    s_lshl_b32 s46, s46, 18
    s_add_u32 s46, s46, s52
    s_add_u32 m0, s53, 102400
    s_nop 0
    buffer_load_dwordx4 v166, s[32:35], s46 offen lds
    s_add_u32 s46, s46, 15360
    buffer_load_dwordx4 v167, s[32:35], s46 offen offset:1024 lds
    s_add_u32 s51, s42, 4
    s_sub_u32 s43, s51, 18
    s_cmp_ge_u32 s51, 18
    s_cselect_b32 s51, s43, s51
    s_lshl_b32 s51, s51, 6
    s_add_u32 m0, s55, 0
    s_nop 0
    buffer_load_dwordx4 v11, s[28:31], s51 offen lds
    s_add_u32 s46, s42, 4
    s_sub_u32 s43, s46, 18
    s_cmp_ge_u32 s46, 18
    s_cselect_b32 s46, s43, s46
    s_lshl_b32 s46, s46, 18
    s_add_u32 s46, s46, s52
    s_add_u32 m0, s53, 0
    s_nop 0
    buffer_load_dwordx4 v166, s[32:35], s46 offen lds
    s_add_u32 s46, s46, 15360
    buffer_load_dwordx4 v167, s[32:35], s46 offen offset:1024 lds
    v_lshrrev_b32 v2, 4, v1
    v_and_b32 v3, 15, v1
    v_lshlrev_b32 v4, 8, v2
    v_lshlrev_b32 v5, 2, v2
    v_xor_b32 v5, v3, v5
    v_lshl_add_u32 v10, v5, 4, v4
    v_xor_b32 v3, v3, v2
    v_xor_b32 v5, 0, v3
    v_lshl_add_u32 v6, v5, 4, v4
    v_xor_b32 v5, 4, v3
    v_lshl_add_u32 v7, v5, 4, v4
    v_xor_b32 v5, 8, v3
    v_lshl_add_u32 v8, v5, 4, v4
    v_xor_b32 v5, 12, v3
    v_lshl_add_u32 v9, v5, 4, v4
    s_mov_b32 s45, 0
    s_add_u32 s46, s50, s45
    s_and_b32 s46, s46, 15
    s_lshl_b32 s46, s46, 14
    s_add_u32 s46, s46, s54
    s_and_b32 s49, s45, 3
    s_lshl_b32 s49, s49, 15
    s_add_u32 m0, s49, s54
    s_add_u32 s49, m0, 16384
    buffer_load_dwordx4 v6, s[20:23], s46 offen offset:0 nt lds
    buffer_load_dwordx4 v7, s[20:23], s46 offen offset:1024 nt lds
    buffer_load_dwordx4 v8, s[20:23], s46 offen offset:2048 nt lds
    buffer_load_dwordx4 v9, s[20:23], s46 offen offset:3072 nt lds
    s_mov_b32 m0, s49
    s_nop 0
    buffer_load_dwordx4 v10, s[24:27], s46 offen offset:0 nt lds
    buffer_load_dwordx4 v10, s[24:27], s46 offen offset:1024 nt lds
    buffer_load_dwordx4 v10, s[24:27], s46 offen offset:2048 nt lds
    buffer_load_dwordx4 v10, s[24:27], s46 offen offset:3072 nt lds
    s_waitcnt vmcnt(20)
    s_barrier
    s_add_u32 s51, s42, 5
    s_sub_u32 s43, s51, 18
    s_cmp_ge_u32 s51, 18
    s_cselect_b32 s51, s43, s51
    s_lshl_b32 s51, s51, 6
    s_add_u32 m0, s55, 20480
    s_nop 0
    buffer_load_dwordx4 v11, s[28:31], s51 offen lds
    s_add_u32 s46, s42, 5
    s_sub_u32 s43, s46, 18
    s_cmp_ge_u32 s46, 18
    s_cselect_b32 s46, s43, s46
    s_lshl_b32 s46, s46, 18
    s_add_u32 s46, s46, s52
    s_add_u32 m0, s53, 20480
    s_nop 0
    buffer_load_dwordx4 v166, s[32:35], s46 offen lds
    s_add_u32 s46, s46, 15360
    buffer_load_dwordx4 v167, s[32:35], s46 offen offset:1024 lds
    s_waitcnt vmcnt(20)
    s_barrier
    s_add_u32 s51, s42, 6
    s_sub_u32 s43, s51, 18
    s_cmp_ge_u32 s51, 18
    s_cselect_b32 s51, s43, s51
    s_lshl_b32 s51, s51, 6
    s_add_u32 m0, s55, 40960
    s_nop 0
    buffer_load_dwordx4 v11, s[28:31], s51 offen lds
    s_add_u32 s46, s42, 6
    s_sub_u32 s43, s46, 18
    s_cmp_ge_u32 s46, 18
    s_cselect_b32 s46, s43, s46
    s_lshl_b32 s46, s46, 18
    s_add_u32 s46, s46, s52
    s_add_u32 m0, s53, 40960
    s_nop 0
    buffer_load_dwordx4 v166, s[32:35], s46 offen lds
    s_add_u32 s46, s46, 15360
    buffer_load_dwordx4 v167, s[32:35], s46 offen offset:1024 lds
    s_waitcnt vmcnt(20)
    s_barrier
    s_add_u32 s51, s42, 7
    s_sub_u32 s43, s51, 18
    s_cmp_ge_u32 s51, 18
    s_cselect_b32 s51, s43, s51
    s_lshl_b32 s51, s51, 6
    s_add_u32 m0, s55, 61440
    s_nop 0
    buffer_load_dwordx4 v11, s[28:31], s51 offen lds
    s_add_u32 s46, s42, 7
    s_sub_u32 s43, s46, 18
    s_cmp_ge_u32 s46, 18
    s_cselect_b32 s46, s43, s46
    s_lshl_b32 s46, s46, 18
    s_add_u32 s46, s46, s52
    s_add_u32 m0, s53, 61440
    s_nop 0
    buffer_load_dwordx4 v166, s[32:35], s46 offen lds
    s_add_u32 s46, s46, 15360
    buffer_load_dwordx4 v167, s[32:35], s46 offen offset:1024 lds
    s_waitcnt vmcnt(20)
    s_barrier
    s_add_u32 s51, s42, 8
    s_sub_u32 s43, s51, 18
    s_cmp_ge_u32 s51, 18
    s_cselect_b32 s51, s43, s51
    s_lshl_b32 s51, s51, 6
    s_add_u32 m0, s55, 81920
    s_nop 0
    buffer_load_dwordx4 v11, s[28:31], s51 offen lds
    s_add_u32 s46, s42, 8
    s_sub_u32 s43, s46, 18
    s_cmp_ge_u32 s46, 18
    s_cselect_b32 s46, s43, s46
    s_lshl_b32 s46, s46, 18
    s_add_u32 s46, s46, s52
    s_add_u32 m0, s53, 81920
    s_nop 0
    buffer_load_dwordx4 v166, s[32:35], s46 offen lds
    s_add_u32 s46, s46, 15360
    buffer_load_dwordx4 v167, s[32:35], s46 offen offset:1024 lds
    s_waitcnt vmcnt(20)
    s_barrier
    s_add_u32 s51, s42, 9
    s_sub_u32 s43, s51, 18
    s_cmp_ge_u32 s51, 18
    s_cselect_b32 s51, s43, s51
    s_lshl_b32 s51, s51, 6
    s_add_u32 m0, s55, 102400
    s_nop 0
    buffer_load_dwordx4 v11, s[28:31], s51 offen lds
    s_add_u32 s46, s42, 9
    s_sub_u32 s43, s46, 18
    s_cmp_ge_u32 s46, 18
    s_cselect_b32 s46, s43, s46
    s_lshl_b32 s46, s46, 18
    s_add_u32 s46, s46, s52
    s_add_u32 m0, s53, 102400
    s_nop 0
    buffer_load_dwordx4 v166, s[32:35], s46 offen lds
    s_add_u32 s46, s46, 15360
    buffer_load_dwordx4 v167, s[32:35], s46 offen offset:1024 lds
    s_waitcnt vmcnt(12)
    s_barrier
    s_add_u32 s51, s42, 10
    s_sub_u32 s43, s51, 18
    s_cmp_ge_u32 s51, 18
    s_cselect_b32 s51, s43, s51
    s_lshl_b32 s51, s51, 6
    s_add_u32 m0, s55, 0
    s_nop 0
    buffer_load_dwordx4 v11, s[28:31], s51 offen lds
    s_add_u32 s46, s42, 10
    s_sub_u32 s43, s46, 18
    s_cmp_ge_u32 s46, 18
    s_cselect_b32 s46, s43, s46
    s_lshl_b32 s46, s46, 18
    s_add_u32 s46, s46, s52
    s_add_u32 m0, s53, 0
    s_nop 0
    buffer_load_dwordx4 v166, s[32:35], s46 offen lds
    s_add_u32 s46, s46, 15360
    buffer_load_dwordx4 v167, s[32:35], s46 offen offset:1024 lds
    s_waitcnt vmcnt(12)
    s_barrier
    s_add_u32 s51, s42, 11
    s_sub_u32 s43, s51, 18
    s_cmp_ge_u32 s51, 18
    s_cselect_b32 s51, s43, s51
    s_lshl_b32 s51, s51, 6
    s_add_u32 m0, s55, 20480
    s_nop 0
    buffer_load_dwordx4 v11, s[28:31], s51 offen lds
    s_add_u32 s46, s42, 11
    s_sub_u32 s43, s46, 18
    s_cmp_ge_u32 s46, 18
    s_cselect_b32 s46, s43, s46
    s_lshl_b32 s46, s46, 18
    s_add_u32 s46, s46, s52
    s_add_u32 m0, s53, 20480
    s_nop 0
    buffer_load_dwordx4 v166, s[32:35], s46 offen lds
    s_add_u32 s46, s46, 15360
    buffer_load_dwordx4 v167, s[32:35], s46 offen offset:1024 lds
    s_waitcnt vmcnt(12)
    s_barrier
    s_add_u32 s51, s42, 12
    s_sub_u32 s43, s51, 18
    s_cmp_ge_u32 s51, 18
    s_cselect_b32 s51, s43, s51
    s_lshl_b32 s51, s51, 6
    s_add_u32 m0, s55, 40960
    s_nop 0
    buffer_load_dwordx4 v11, s[28:31], s51 offen lds
    s_add_u32 s46, s42, 12
    s_sub_u32 s43, s46, 18
    s_cmp_ge_u32 s46, 18
    s_cselect_b32 s46, s43, s46
    s_lshl_b32 s46, s46, 18
    s_add_u32 s46, s46, s52
    s_add_u32 m0, s53, 40960
    s_nop 0
    buffer_load_dwordx4 v166, s[32:35], s46 offen lds
    s_add_u32 s46, s46, 15360
    buffer_load_dwordx4 v167, s[32:35], s46 offen offset:1024 lds
    s_waitcnt vmcnt(12)
    s_barrier
    s_add_u32 s51, s42, 13
    s_sub_u32 s43, s51, 18
    s_cmp_ge_u32 s51, 18
    s_cselect_b32 s51, s43, s51
    s_lshl_b32 s51, s51, 6
    s_add_u32 m0, s55, 61440
    s_nop 0
    buffer_load_dwordx4 v11, s[28:31], s51 offen lds
    s_add_u32 s46, s42, 13
    s_sub_u32 s43, s46, 18
    s_cmp_ge_u32 s46, 18
    s_cselect_b32 s46, s43, s46
    s_lshl_b32 s46, s46, 18
    s_add_u32 s46, s46, s52
    s_add_u32 m0, s53, 61440
    s_nop 0
    buffer_load_dwordx4 v166, s[32:35], s46 offen lds
    s_add_u32 s46, s46, 15360
    buffer_load_dwordx4 v167, s[32:35], s46 offen offset:1024 lds
    s_waitcnt vmcnt(12)
    s_barrier
    s_add_u32 s51, s42, 14
    s_sub_u32 s43, s51, 18
    s_cmp_ge_u32 s51, 18
    s_cselect_b32 s51, s43, s51
    s_lshl_b32 s51, s51, 6
    s_add_u32 m0, s55, 81920
    s_nop 0
    buffer_load_dwordx4 v11, s[28:31], s51 offen lds
    s_add_u32 s46, s42, 14
    s_sub_u32 s43, s46, 18
    s_cmp_ge_u32 s46, 18
    s_cselect_b32 s46, s43, s46
    s_lshl_b32 s46, s46, 18
    s_add_u32 s46, s46, s52
    s_add_u32 m0, s53, 81920
    s_nop 0
    buffer_load_dwordx4 v166, s[32:35], s46 offen lds
    s_add_u32 s46, s46, 15360
    buffer_load_dwordx4 v167, s[32:35], s46 offen offset:1024 lds
    s_waitcnt vmcnt(12)
    s_barrier
    s_add_u32 s51, s42, 15
    s_sub_u32 s43, s51, 18
    s_cmp_ge_u32 s51, 18
    s_cselect_b32 s51, s43, s51
    s_lshl_b32 s51, s51, 6
    s_add_u32 m0, s55, 102400
    s_nop 0
    buffer_load_dwordx4 v11, s[28:31], s51 offen lds
    s_add_u32 s46, s42, 15
    s_sub_u32 s43, s46, 18
    s_cmp_ge_u32 s46, 18
    s_cselect_b32 s46, s43, s46
    s_lshl_b32 s46, s46, 18
    s_add_u32 s46, s46, s52
    s_add_u32 m0, s53, 102400
    s_nop 0
    buffer_load_dwordx4 v166, s[32:35], s46 offen lds
    s_add_u32 s46, s46, 15360
    buffer_load_dwordx4 v167, s[32:35], s46 offen offset:1024 lds
    s_waitcnt vmcnt(12)
    s_barrier
    s_add_u32 s51, s42, 16
    s_sub_u32 s43, s51, 18
    s_cmp_ge_u32 s51, 18
    s_cselect_b32 s51, s43, s51
    s_lshl_b32 s51, s51, 6
    s_add_u32 m0, s55, 0
    s_nop 0
    buffer_load_dwordx4 v11, s[28:31], s51 offen lds
    s_add_u32 s46, s42, 16
    s_sub_u32 s43, s46, 18
    s_cmp_ge_u32 s46, 18
    s_cselect_b32 s46, s43, s46
    s_lshl_b32 s46, s46, 18
    s_add_u32 s46, s46, s52
    s_add_u32 m0, s53, 0
    s_nop 0
    buffer_load_dwordx4 v166, s[32:35], s46 offen lds
    s_add_u32 s46, s46, 15360
    buffer_load_dwordx4 v167, s[32:35], s46 offen offset:1024 lds
    s_waitcnt vmcnt(12)
    s_barrier
    s_add_u32 s51, s42, 17
    s_sub_u32 s43, s51, 18
    s_cmp_ge_u32 s51, 18
    s_cselect_b32 s51, s43, s51
    s_lshl_b32 s51, s51, 6
    s_add_u32 m0, s55, 20480
    s_nop 0
    buffer_load_dwordx4 v11, s[28:31], s51 offen lds
    s_add_u32 s46, s42, 17
    s_sub_u32 s43, s46, 18
    s_cmp_ge_u32 s46, 18
    s_cselect_b32 s46, s43, s46
    s_lshl_b32 s46, s46, 18
    s_add_u32 s46, s46, s52
    s_add_u32 m0, s53, 20480
    s_nop 0
    buffer_load_dwordx4 v166, s[32:35], s46 offen lds
    s_add_u32 s46, s46, 15360
    buffer_load_dwordx4 v167, s[32:35], s46 offen offset:1024 lds
    s_mov_b32 s76, s12
    s_mov_b32 s77, s13
    s_mov_b32 s78, 4718592
    s_mov_b32 s79, 0x20000
    s_mul_i32 s43, s2, 18432
    s_mul_i32 s46, s40, 5120
    s_add_u32 s43, s43, s46
    s_sub_u32 s43, s43, 40960
    v_lshlrev_b32 v12, 4, v1
    v_add_u32 v12, s43, v12
    v_add_u32 v13, 4096, v12
    buffer_load_dwordx4 v[20:23], v12, s[76:79], 0 offen offset:0
    buffer_load_dwordx4 v[24:27], v12, s[76:79], 0 offen offset:1024
    buffer_load_dwordx4 v[28:31], v12, s[76:79], 0 offen offset:2048
    buffer_load_dwordx4 v[32:35], v12, s[76:79], 0 offen offset:3072
    buffer_load_dwordx4 v[36:39], v13, s[76:79], 0 offen
    s_waitcnt vmcnt(17)
    s_barrier
    s_waitcnt vmcnt(14)
    s_barrier
    s_waitcnt vmcnt(11)
    s_barrier
    s_waitcnt vmcnt(8)
    s_barrier
    s_waitcnt vmcnt(5)
    s_barrier
    s_barrier
    s_mov_b32 s45, 1
attn_ldpro:
    s_add_u32 s46, s50, s45
    s_and_b32 s46, s46, 15
    s_lshl_b32 s46, s46, 14
    s_add_u32 s46, s46, s54
    s_and_b32 s49, s45, 3
    s_lshl_b32 s49, s49, 15
    s_add_u32 m0, s49, s54
    s_add_u32 s49, m0, 16384
    buffer_load_dwordx4 v6, s[20:23], s46 offen offset:0 nt lds
    buffer_load_dwordx4 v7, s[20:23], s46 offen offset:1024 nt lds
    buffer_load_dwordx4 v8, s[20:23], s46 offen offset:2048 nt lds
    buffer_load_dwordx4 v9, s[20:23], s46 offen offset:3072 nt lds
    s_mov_b32 m0, s49
    s_nop 0
    buffer_load_dwordx4 v10, s[24:27], s46 offen offset:0 nt lds
    buffer_load_dwordx4 v10, s[24:27], s46 offen offset:1024 nt lds
    buffer_load_dwordx4 v10, s[24:27], s46 offen offset:2048 nt lds
    buffer_load_dwordx4 v10, s[24:27], s46 offen offset:3072 nt lds
    s_add_u32 s45, s45, 1
    s_cmp_lt_u32 s45, 3
    s_cbranch_scc1 attn_ldpro
    s_mov_b32 s48, 0
attn_ldloop:
    s_cmp_lt_u32 s48, 14
    s_cbranch_scc1 attn_ldw32
    s_cmp_eq_u32 s48, 14
    s_cbranch_scc1 attn_ldw16
    s_waitcnt vmcnt(0)
    s_branch attn_ldw
attn_ldw16:
    s_waitcnt vmcnt(8)
    s_branch attn_ldw
attn_ldw32:
    s_waitcnt vmcnt(16)
attn_ldw:
    s_barrier
    s_add_u32 s45, s48, 3
    s_cmp_ge_u32 s45, 16
    s_cbranch_scc1 attn_ldskip
    s_add_u32 s46, s50, s45
    s_and_b32 s46, s46, 15
    s_lshl_b32 s46, s46, 14
    s_add_u32 s46, s46, s54
    s_and_b32 s49, s45, 3
    s_lshl_b32 s49, s49, 15
    s_add_u32 m0, s49, s54
    s_add_u32 s49, m0, 16384
    buffer_load_dwordx4 v6, s[20:23], s46 offen offset:0 nt lds
    buffer_load_dwordx4 v7, s[20:23], s46 offen offset:1024 nt lds
    buffer_load_dwordx4 v8, s[20:23], s46 offen offset:2048 nt lds
    buffer_load_dwordx4 v9, s[20:23], s46 offen offset:3072 nt lds
    s_mov_b32 m0, s49
    s_nop 0
    buffer_load_dwordx4 v10, s[24:27], s46 offen offset:0 nt lds
    buffer_load_dwordx4 v10, s[24:27], s46 offen offset:1024 nt lds
    buffer_load_dwordx4 v10, s[24:27], s46 offen offset:2048 nt lds
    buffer_load_dwordx4 v10, s[24:27], s46 offen offset:3072 nt lds
attn_ldskip:
    s_add_u32 s48, s48, 1
    s_cmp_lt_u32 s48, 16
    s_cbranch_scc1 attn_ldloop
    s_barrier
    s_barrier
attn_end:
    s_endpgm
.globl oproj_kernel
.p2align 8
.type oproj_kernel,@function
oproj_kernel:
    s_cmp_ge_u32 s2, 144
    s_cbranch_scc1 oproj_end
    s_load_dwordx4 s[4:7], s[0:1], 32
    s_load_dwordx2 s[16:17], s[0:1], 56
    v_and_b32 v1, 63, v0
    v_lshrrev_b32 v2, 6, v0
    s_nop 0
    v_readfirstlane_b32 s40, v2
    s_and_b32 s41, s2, 15
    s_lshr_b32 s42, s2, 4
    s_waitcnt lgkmcnt(0)
    s_mov_b32 s20, s16
    s_mov_b32 s21, s17
    s_mov_b32 s22, 0x800000
    s_mov_b32 s23, 0x20000
    s_mov_b32 s24, s4
    s_mov_b32 s25, s5
    s_mov_b32 s26, 4718592
    s_mov_b32 s27, 0x20000
    s_mov_b32 s28, s6
    s_mov_b32 s29, s7
    s_mov_b32 s30, 1179648
    s_mov_b32 s31, 0x20000
    v_lshrrev_b32 v2, 3, v1
    s_movk_i32 s43, 1152
    v_mul_lo_u32 v2, v2, s43
    v_and_b32 v3, 7, v1
    v_bfe_u32 v4, v1, 4, 1
    v_lshlrev_b32 v4, 2, v4
    v_xor_b32 v3, v3, v4
    v_lshl_add_u32 v6, v3, 4, v2
    s_mul_i32 s47, s40, 589824
    s_lshl_b32 s43, s42, 7
    s_add_u32 s47, s47, s43
    s_lshl_b32 s43, s41, 19
    s_lshl_b32 s44, s40, 15
    s_add_u32 s43, s43, s44
    v_lshlrev_b32 v2, 4, v1
    v_add_u32 v10, s43, v2
    v_add_u32 v11, 0x40000, v10
    s_lshl_b32 s48, s40, 14
    s_mov_b32 s46, s47
    s_mov_b32 s50, 0
    s_add_u32 m0, s48, 0
    s_nop 0
    buffer_load_dwordx4 v6, s[24:27], s46 offen lds
    s_add_u32 s46, s46, 9216
    s_add_u32 m0, s48, 1024
    s_nop 0
    buffer_load_dwordx4 v6, s[24:27], s46 offen lds
    s_add_u32 s46, s46, 9216
    s_add_u32 m0, s48, 2048
    s_nop 0
    buffer_load_dwordx4 v6, s[24:27], s46 offen lds
    s_add_u32 s46, s46, 9216
    s_add_u32 m0, s48, 3072
    s_nop 0
    buffer_load_dwordx4 v6, s[24:27], s46 offen lds
    s_add_u32 s46, s46, 9216
    buffer_load_dwordx4 v[128:131], v10, s[20:23], s50 offen offset:0
    buffer_load_dwordx4 v[132:135], v10, s[20:23], s50 offen offset:1024
    buffer_load_dwordx4 v[136:139], v11, s[20:23], s50 offen offset:0
    buffer_load_dwordx4 v[140:143], v11, s[20:23], s50 offen offset:1024
    s_add_u32 s50, s50, 2048
    s_add_u32 m0, s48, 4096
    s_nop 0
    buffer_load_dwordx4 v6, s[24:27], s46 offen lds
    s_add_u32 s46, s46, 9216
    s_add_u32 m0, s48, 5120
    s_nop 0
    buffer_load_dwordx4 v6, s[24:27], s46 offen lds
    s_add_u32 s46, s46, 9216
    s_add_u32 m0, s48, 6144
    s_nop 0
    buffer_load_dwordx4 v6, s[24:27], s46 offen lds
    s_add_u32 s46, s46, 9216
    s_add_u32 m0, s48, 7168
    s_nop 0
    buffer_load_dwordx4 v6, s[24:27], s46 offen lds
    s_add_u32 s46, s46, 9216
    buffer_load_dwordx4 v[144:147], v10, s[20:23], s50 offen offset:0
    buffer_load_dwordx4 v[148:151], v10, s[20:23], s50 offen offset:1024
    buffer_load_dwordx4 v[152:155], v11, s[20:23], s50 offen offset:0
    buffer_load_dwordx4 v[156:159], v11, s[20:23], s50 offen offset:1024
    s_add_u32 s50, s50, 2048
    s_add_u32 m0, s48, 8192
    s_nop 0
    buffer_load_dwordx4 v6, s[24:27], s46 offen lds
    s_add_u32 s46, s46, 9216
    s_add_u32 m0, s48, 9216
    s_nop 0
    buffer_load_dwordx4 v6, s[24:27], s46 offen lds
    s_add_u32 s46, s46, 9216
    s_add_u32 m0, s48, 10240
    s_nop 0
    buffer_load_dwordx4 v6, s[24:27], s46 offen lds
    s_add_u32 s46, s46, 9216
    s_add_u32 m0, s48, 11264
    s_nop 0
    buffer_load_dwordx4 v6, s[24:27], s46 offen lds
    s_add_u32 s46, s46, 9216
    buffer_load_dwordx4 v[160:163], v10, s[20:23], s50 offen offset:0
    buffer_load_dwordx4 v[164:167], v10, s[20:23], s50 offen offset:1024
    buffer_load_dwordx4 v[168:171], v11, s[20:23], s50 offen offset:0
    buffer_load_dwordx4 v[172:175], v11, s[20:23], s50 offen offset:1024
    s_add_u32 s50, s50, 2048
    v_lshrrev_b32 v2, 5, v1
    v_bfe_u32 v3, v1, 2, 2
    v_lshl_add_u32 v4, v2, 3, v3
    v_lshlrev_b32 v4, 7, v4
    v_bfe_u32 v2, v1, 4, 1
    v_bfe_u32 v5, v1, 1, 1
    v_lshl_add_u32 v2, v2, 1, v5
    v_lshl_add_u32 v4, v2, 4, v4
    v_and_b32 v5, 1, v1
    v_lshl_add_u32 v4, v5, 3, v4
    v_add_u32 v4, s48, v4
    v_bfe_u32 v3, v1, 3, 1
    v_xor_b32 v5, 0, v3
    v_lshl_add_u32 v8, v5, 6, v4
    v_xor_b32 v5, 1, v3
    v_lshl_add_u32 v9, v5, 6, v4
    v_mov_b32 v64, 0
    v_mov_b32 v65, 0
    v_mov_b32 v66, 0
    v_mov_b32 v67, 0
    v_mov_b32 v68, 0
    v_mov_b32 v69, 0
    v_mov_b32 v70, 0
    v_mov_b32 v71, 0
    v_mov_b32 v72, 0
    v_mov_b32 v73, 0
    v_mov_b32 v74, 0
    v_mov_b32 v75, 0
    v_mov_b32 v76, 0
    v_mov_b32 v77, 0
    v_mov_b32 v78, 0
    v_mov_b32 v79, 0
    v_mov_b32 v80, 0
    v_mov_b32 v81, 0
    v_mov_b32 v82, 0
    v_mov_b32 v83, 0
    v_mov_b32 v84, 0
    v_mov_b32 v85, 0
    v_mov_b32 v86, 0
    v_mov_b32 v87, 0
    v_mov_b32 v88, 0
    v_mov_b32 v89, 0
    v_mov_b32 v90, 0
    v_mov_b32 v91, 0
    v_mov_b32 v92, 0
    v_mov_b32 v93, 0
    v_mov_b32 v94, 0
    v_mov_b32 v95, 0
    v_mov_b32 v96, 0
    v_mov_b32 v97, 0
    v_mov_b32 v98, 0
    v_mov_b32 v99, 0
    v_mov_b32 v100, 0
    v_mov_b32 v101, 0
    v_mov_b32 v102, 0
    v_mov_b32 v103, 0
    v_mov_b32 v104, 0
    v_mov_b32 v105, 0
    v_mov_b32 v106, 0
    v_mov_b32 v107, 0
    v_mov_b32 v108, 0
    v_mov_b32 v109, 0
    v_mov_b32 v110, 0
    v_mov_b32 v111, 0
    v_mov_b32 v112, 0
    v_mov_b32 v113, 0
    v_mov_b32 v114, 0
    v_mov_b32 v115, 0
    v_mov_b32 v116, 0
    v_mov_b32 v117, 0
    v_mov_b32 v118, 0
    v_mov_b32 v119, 0
    v_mov_b32 v120, 0
    v_mov_b32 v121, 0
    v_mov_b32 v122, 0
    v_mov_b32 v123, 0
    v_mov_b32 v124, 0
    v_mov_b32 v125, 0
    v_mov_b32 v126, 0
    v_mov_b32 v127, 0
    s_waitcnt vmcnt(16)
    ds_read_b64_tr_b16 v[16:17], v8 offset:0
    ds_read_b64_tr_b16 v[18:19], v8 offset:512
    ds_read_b64_tr_b16 v[20:21], v8 offset:2048
    ds_read_b64_tr_b16 v[22:23], v8 offset:2560
    ds_read_b64_tr_b16 v[24:25], v9 offset:0
    ds_read_b64_tr_b16 v[26:27], v9 offset:512
    ds_read_b64_tr_b16 v[28:29], v9 offset:2048
    ds_read_b64_tr_b16 v[30:31], v9 offset:2560
    s_mov_b32 s49, 0
oproj_loop:
    s_waitcnt lgkmcnt(0)
    s_add_u32 m0, s48, 12288
    s_nop 0
    buffer_load_dwordx4 v6, s[24:27], s46 offen lds
    s_add_u32 s46, s46, 9216
    s_add_u32 m0, s48, 13312
    s_nop 0
    buffer_load_dwordx4 v6, s[24:27], s46 offen lds
    s_add_u32 s46, s46, 9216
    s_add_u32 m0, s48, 14336
    s_nop 0
    buffer_load_dwordx4 v6, s[24:27], s46 offen lds
    s_add_u32 s46, s46, 9216
    s_add_u32 m0, s48, 15360
    s_nop 0
    buffer_load_dwordx4 v6, s[24:27], s46 offen lds
    s_add_u32 s46, s46, 9216
    buffer_load_dwordx4 v[176:179], v10, s[20:23], s50 offen offset:0
    buffer_load_dwordx4 v[180:183], v10, s[20:23], s50 offen offset:1024
    buffer_load_dwordx4 v[184:187], v11, s[20:23], s50 offen offset:0
    buffer_load_dwordx4 v[188:191], v11, s[20:23], s50 offen offset:1024
    s_add_u32 s50, s50, 2048
    s_waitcnt vmcnt(16)
    ds_read_b64_tr_b16 v[32:33], v8 offset:4096
    ds_read_b64_tr_b16 v[34:35], v8 offset:4608
    ds_read_b64_tr_b16 v[36:37], v8 offset:6144
    ds_read_b64_tr_b16 v[38:39], v8 offset:6656
    ds_read_b64_tr_b16 v[40:41], v9 offset:4096
    ds_read_b64_tr_b16 v[42:43], v9 offset:4608
    ds_read_b64_tr_b16 v[44:45], v9 offset:6144
    ds_read_b64_tr_b16 v[46:47], v9 offset:6656
    v_mfma_f32_32x32x16_bf16 v[64:79], v[16:19], v[128:131], v[64:79]
    v_mfma_f32_32x32x16_bf16 v[80:95], v[16:19], v[136:139], v[80:95]
    v_mfma_f32_32x32x16_bf16 v[96:111], v[24:27], v[128:131], v[96:111]
    v_mfma_f32_32x32x16_bf16 v[112:127], v[24:27], v[136:139], v[112:127]
    v_mfma_f32_32x32x16_bf16 v[64:79], v[20:23], v[132:135], v[64:79]
    v_mfma_f32_32x32x16_bf16 v[80:95], v[20:23], v[140:143], v[80:95]
    v_mfma_f32_32x32x16_bf16 v[96:111], v[28:31], v[132:135], v[96:111]
    v_mfma_f32_32x32x16_bf16 v[112:127], v[28:31], v[140:143], v[112:127]
    s_waitcnt lgkmcnt(0)
    s_add_u32 m0, s48, 0
    s_nop 0
    buffer_load_dwordx4 v6, s[24:27], s46 offen lds
    s_add_u32 s46, s46, 9216
    s_add_u32 m0, s48, 1024
    s_nop 0
    buffer_load_dwordx4 v6, s[24:27], s46 offen lds
    s_add_u32 s46, s46, 9216
    s_add_u32 m0, s48, 2048
    s_nop 0
    buffer_load_dwordx4 v6, s[24:27], s46 offen lds
    s_add_u32 s46, s46, 9216
    s_add_u32 m0, s48, 3072
    s_nop 0
    buffer_load_dwordx4 v6, s[24:27], s46 offen lds
    s_add_u32 s46, s46, 9216
    buffer_load_dwordx4 v[128:131], v10, s[20:23], s50 offen offset:0
    buffer_load_dwordx4 v[132:135], v10, s[20:23], s50 offen offset:1024
    buffer_load_dwordx4 v[136:139], v11, s[20:23], s50 offen offset:0
    buffer_load_dwordx4 v[140:143], v11, s[20:23], s50 offen offset:1024
    s_add_u32 s50, s50, 2048
    s_waitcnt vmcnt(16)
    ds_read_b64_tr_b16 v[16:17], v8 offset:8192
    ds_read_b64_tr_b16 v[18:19], v8 offset:8704
    ds_read_b64_tr_b16 v[20:21], v8 offset:10240
    ds_read_b64_tr_b16 v[22:23], v8 offset:10752
    ds_read_b64_tr_b16 v[24:25], v9 offset:8192
    ds_read_b64_tr_b16 v[26:27], v9 offset:8704
    ds_read_b64_tr_b16 v[28:29], v9 offset:10240
    ds_read_b64_tr_b16 v[30:31], v9 offset:10752
    v_mfma_f32_32x32x16_bf16 v[64:79], v[32:35], v[144:147], v[64:79]
    v_mfma_f32_32x32x16_bf16 v[80:95], v[32:35], v[152:155], v[80:95]
    v_mfma_f32_32x32x16_bf16 v[96:111], v[40:43], v[144:147], v[96:111]
    v_mfma_f32_32x32x16_bf16 v[112:127], v[40:43], v[152:155], v[112:127]
    v_mfma_f32_32x32x16_bf16 v[64:79], v[36:39], v[148:151], v[64:79]
    v_mfma_f32_32x32x16_bf16 v[80:95], v[36:39], v[156:159], v[80:95]
    v_mfma_f32_32x32x16_bf16 v[96:111], v[44:47], v[148:151], v[96:111]
    v_mfma_f32_32x32x16_bf16 v[112:127], v[44:47], v[156:159], v[112:127]
    s_waitcnt lgkmcnt(0)
    s_add_u32 m0, s48, 4096
    s_nop 0
    buffer_load_dwordx4 v6, s[24:27], s46 offen lds
    s_add_u32 s46, s46, 9216
    s_add_u32 m0, s48, 5120
    s_nop 0
    buffer_load_dwordx4 v6, s[24:27], s46 offen lds
    s_add_u32 s46, s46, 9216
    s_add_u32 m0, s48, 6144
    s_nop 0
    buffer_load_dwordx4 v6, s[24:27], s46 offen lds
    s_add_u32 s46, s46, 9216
    s_add_u32 m0, s48, 7168
    s_nop 0
    buffer_load_dwordx4 v6, s[24:27], s46 offen lds
    s_add_u32 s46, s46, 9216
    buffer_load_dwordx4 v[144:147], v10, s[20:23], s50 offen offset:0
    buffer_load_dwordx4 v[148:151], v10, s[20:23], s50 offen offset:1024
    buffer_load_dwordx4 v[152:155], v11, s[20:23], s50 offen offset:0
    buffer_load_dwordx4 v[156:159], v11, s[20:23], s50 offen offset:1024
    s_add_u32 s50, s50, 2048
    s_waitcnt vmcnt(16)
    ds_read_b64_tr_b16 v[32:33], v8 offset:12288
    ds_read_b64_tr_b16 v[34:35], v8 offset:12800
    ds_read_b64_tr_b16 v[36:37], v8 offset:14336
    ds_read_b64_tr_b16 v[38:39], v8 offset:14848
    ds_read_b64_tr_b16 v[40:41], v9 offset:12288
    ds_read_b64_tr_b16 v[42:43], v9 offset:12800
    ds_read_b64_tr_b16 v[44:45], v9 offset:14336
    ds_read_b64_tr_b16 v[46:47], v9 offset:14848
    v_mfma_f32_32x32x16_bf16 v[64:79], v[16:19], v[160:163], v[64:79]
    v_mfma_f32_32x32x16_bf16 v[80:95], v[16:19], v[168:171], v[80:95]
    v_mfma_f32_32x32x16_bf16 v[96:111], v[24:27], v[160:163], v[96:111]
    v_mfma_f32_32x32x16_bf16 v[112:127], v[24:27], v[168:171], v[112:127]
    v_mfma_f32_32x32x16_bf16 v[64:79], v[20:23], v[164:167], v[64:79]
    v_mfma_f32_32x32x16_bf16 v[80:95], v[20:23], v[172:175], v[80:95]
    v_mfma_f32_32x32x16_bf16 v[96:111], v[28:31], v[164:167], v[96:111]
    v_mfma_f32_32x32x16_bf16 v[112:127], v[28:31], v[172:175], v[112:127]
    s_waitcnt lgkmcnt(0)
    s_add_u32 m0, s48, 8192
    s_nop 0
    buffer_load_dwordx4 v6, s[24:27], s46 offen lds
    s_add_u32 s46, s46, 9216
    s_add_u32 m0, s48, 9216
    s_nop 0
    buffer_load_dwordx4 v6, s[24:27], s46 offen lds
    s_add_u32 s46, s46, 9216
    s_add_u32 m0, s48, 10240
    s_nop 0
    buffer_load_dwordx4 v6, s[24:27], s46 offen lds
    s_add_u32 s46, s46, 9216
    s_add_u32 m0, s48, 11264
    s_nop 0
    buffer_load_dwordx4 v6, s[24:27], s46 offen lds
    s_add_u32 s46, s46, 9216
    buffer_load_dwordx4 v[160:163], v10, s[20:23], s50 offen offset:0
    buffer_load_dwordx4 v[164:167], v10, s[20:23], s50 offen offset:1024
    buffer_load_dwordx4 v[168:171], v11, s[20:23], s50 offen offset:0
    buffer_load_dwordx4 v[172:175], v11, s[20:23], s50 offen offset:1024
    s_add_u32 s50, s50, 2048
    s_waitcnt vmcnt(16)
    ds_read_b64_tr_b16 v[16:17], v8 offset:0
    ds_read_b64_tr_b16 v[18:19], v8 offset:512
    ds_read_b64_tr_b16 v[20:21], v8 offset:2048
    ds_read_b64_tr_b16 v[22:23], v8 offset:2560
    ds_read_b64_tr_b16 v[24:25], v9 offset:0
    ds_read_b64_tr_b16 v[26:27], v9 offset:512
    ds_read_b64_tr_b16 v[28:29], v9 offset:2048
    ds_read_b64_tr_b16 v[30:31], v9 offset:2560
    v_mfma_f32_32x32x16_bf16 v[64:79], v[32:35], v[176:179], v[64:79]
    v_mfma_f32_32x32x16_bf16 v[80:95], v[32:35], v[184:187], v[80:95]
    v_mfma_f32_32x32x16_bf16 v[96:111], v[40:43], v[176:179], v[96:111]
    v_mfma_f32_32x32x16_bf16 v[112:127], v[40:43], v[184:187], v[112:127]
    v_mfma_f32_32x32x16_bf16 v[64:79], v[36:39], v[180:183], v[64:79]
    v_mfma_f32_32x32x16_bf16 v[80:95], v[36:39], v[188:191], v[80:95]
    v_mfma_f32_32x32x16_bf16 v[96:111], v[44:47], v[180:183], v[96:111]
    v_mfma_f32_32x32x16_bf16 v[112:127], v[44:47], v[188:191], v[112:127]
    s_add_u32 s49, s49, 1
    s_cmp_lt_u32 s49, 3
    s_cbranch_scc1 oproj_loop
    s_waitcnt lgkmcnt(0)
    s_add_u32 m0, s48, 12288
    s_nop 0
    buffer_load_dwordx4 v6, s[24:27], s46 offen lds
    s_add_u32 s46, s46, 9216
    s_add_u32 m0, s48, 13312
    s_nop 0
    buffer_load_dwordx4 v6, s[24:27], s46 offen lds
    s_add_u32 s46, s46, 9216
    s_add_u32 m0, s48, 14336
    s_nop 0
    buffer_load_dwordx4 v6, s[24:27], s46 offen lds
    s_add_u32 s46, s46, 9216
    s_add_u32 m0, s48, 15360
    s_nop 0
    buffer_load_dwordx4 v6, s[24:27], s46 offen lds
    s_add_u32 s46, s46, 9216
    buffer_load_dwordx4 v[176:179], v10, s[20:23], s50 offen offset:0
    buffer_load_dwordx4 v[180:183], v10, s[20:23], s50 offen offset:1024
    buffer_load_dwordx4 v[184:187], v11, s[20:23], s50 offen offset:0
    buffer_load_dwordx4 v[188:191], v11, s[20:23], s50 offen offset:1024
    s_add_u32 s50, s50, 2048
    s_waitcnt vmcnt(16)
    ds_read_b64_tr_b16 v[32:33], v8 offset:4096
    ds_read_b64_tr_b16 v[34:35], v8 offset:4608
    ds_read_b64_tr_b16 v[36:37], v8 offset:6144
    ds_read_b64_tr_b16 v[38:39], v8 offset:6656
    ds_read_b64_tr_b16 v[40:41], v9 offset:4096
    ds_read_b64_tr_b16 v[42:43], v9 offset:4608
    ds_read_b64_tr_b16 v[44:45], v9 offset:6144
    ds_read_b64_tr_b16 v[46:47], v9 offset:6656
    v_mfma_f32_32x32x16_bf16 v[64:79], v[16:19], v[128:131], v[64:79]
    v_mfma_f32_32x32x16_bf16 v[80:95], v[16:19], v[136:139], v[80:95]
    v_mfma_f32_32x32x16_bf16 v[96:111], v[24:27], v[128:131], v[96:111]
    v_mfma_f32_32x32x16_bf16 v[112:127], v[24:27], v[136:139], v[112:127]
    v_mfma_f32_32x32x16_bf16 v[64:79], v[20:23], v[132:135], v[64:79]
    v_mfma_f32_32x32x16_bf16 v[80:95], v[20:23], v[140:143], v[80:95]
    v_mfma_f32_32x32x16_bf16 v[96:111], v[28:31], v[132:135], v[96:111]
    v_mfma_f32_32x32x16_bf16 v[112:127], v[28:31], v[140:143], v[112:127]
    s_waitcnt lgkmcnt(0)
    s_waitcnt vmcnt(8)
    ds_read_b64_tr_b16 v[16:17], v8 offset:8192
    ds_read_b64_tr_b16 v[18:19], v8 offset:8704
    ds_read_b64_tr_b16 v[20:21], v8 offset:10240
    ds_read_b64_tr_b16 v[22:23], v8 offset:10752
    ds_read_b64_tr_b16 v[24:25], v9 offset:8192
    ds_read_b64_tr_b16 v[26:27], v9 offset:8704
    ds_read_b64_tr_b16 v[28:29], v9 offset:10240
    ds_read_b64_tr_b16 v[30:31], v9 offset:10752
    v_mfma_f32_32x32x16_bf16 v[64:79], v[32:35], v[144:147], v[64:79]
    v_mfma_f32_32x32x16_bf16 v[80:95], v[32:35], v[152:155], v[80:95]
    v_mfma_f32_32x32x16_bf16 v[96:111], v[40:43], v[144:147], v[96:111]
    v_mfma_f32_32x32x16_bf16 v[112:127], v[40:43], v[152:155], v[112:127]
    v_mfma_f32_32x32x16_bf16 v[64:79], v[36:39], v[148:151], v[64:79]
    v_mfma_f32_32x32x16_bf16 v[80:95], v[36:39], v[156:159], v[80:95]
    v_mfma_f32_32x32x16_bf16 v[96:111], v[44:47], v[148:151], v[96:111]
    v_mfma_f32_32x32x16_bf16 v[112:127], v[44:47], v[156:159], v[112:127]
    s_waitcnt lgkmcnt(0)
    s_waitcnt vmcnt(0)
    ds_read_b64_tr_b16 v[32:33], v8 offset:12288
    ds_read_b64_tr_b16 v[34:35], v8 offset:12800
    ds_read_b64_tr_b16 v[36:37], v8 offset:14336
    ds_read_b64_tr_b16 v[38:39], v8 offset:14848
    ds_read_b64_tr_b16 v[40:41], v9 offset:12288
    ds_read_b64_tr_b16 v[42:43], v9 offset:12800
    ds_read_b64_tr_b16 v[44:45], v9 offset:14336
    ds_read_b64_tr_b16 v[46:47], v9 offset:14848
    v_mfma_f32_32x32x16_bf16 v[64:79], v[16:19], v[160:163], v[64:79]
    v_mfma_f32_32x32x16_bf16 v[80:95], v[16:19], v[168:171], v[80:95]
    v_mfma_f32_32x32x16_bf16 v[96:111], v[24:27], v[160:163], v[96:111]
    v_mfma_f32_32x32x16_bf16 v[112:127], v[24:27], v[168:171], v[112:127]
    v_mfma_f32_32x32x16_bf16 v[64:79], v[20:23], v[164:167], v[64:79]
    v_mfma_f32_32x32x16_bf16 v[80:95], v[20:23], v[172:175], v[80:95]
    v_mfma_f32_32x32x16_bf16 v[96:111], v[28:31], v[164:167], v[96:111]
    v_mfma_f32_32x32x16_bf16 v[112:127], v[28:31], v[172:175], v[112:127]
    s_waitcnt lgkmcnt(0)
    v_mfma_f32_32x32x16_bf16 v[64:79], v[32:35], v[176:179], v[64:79]
    v_mfma_f32_32x32x16_bf16 v[80:95], v[32:35], v[184:187], v[80:95]
    v_mfma_f32_32x32x16_bf16 v[96:111], v[40:43], v[176:179], v[96:111]
    v_mfma_f32_32x32x16_bf16 v[112:127], v[40:43], v[184:187], v[112:127]
    v_mfma_f32_32x32x16_bf16 v[64:79], v[36:39], v[180:183], v[64:79]
    v_mfma_f32_32x32x16_bf16 v[80:95], v[36:39], v[188:191], v[80:95]
    v_mfma_f32_32x32x16_bf16 v[96:111], v[44:47], v[180:183], v[96:111]
    v_mfma_f32_32x32x16_bf16 v[112:127], v[44:47], v[188:191], v[112:127]
    s_nop 15
    s_barrier
    v_lshlrev_b32 v2, 4, v1
    v_add_u32 v3, s48, v2
    ds_write_b128 v3, v[64:67] offset:0
    ds_write_b128 v3, v[68:71] offset:1024
    ds_write_b128 v3, v[72:75] offset:2048
    ds_write_b128 v3, v[76:79] offset:3072
    ds_write_b128 v3, v[80:83] offset:4096
    ds_write_b128 v3, v[84:87] offset:5120
    ds_write_b128 v3, v[88:91] offset:6144
    ds_write_b128 v3, v[92:95] offset:7168
    ds_write_b128 v3, v[96:99] offset:8192
    ds_write_b128 v3, v[100:103] offset:9216
    ds_write_b128 v3, v[104:107] offset:10240
    ds_write_b128 v3, v[108:111] offset:11264
    ds_write_b128 v3, v[112:115] offset:12288
    ds_write_b128 v3, v[116:119] offset:13312
    ds_write_b128 v3, v[120:123] offset:14336
    ds_write_b128 v3, v[124:127] offset:15360
    s_waitcnt lgkmcnt(0)
    s_barrier
    s_lshl_b32 s43, s40, 11
    v_add_u32 v3, s43, v2
    v_add_u32 v4, 0x10000, v3
    ds_read_b128 v[128:131], v3 offset:0
    ds_read_b128 v[132:135], v3 offset:1024
    ds_read_b128 v[136:139], v3 offset:16384
    ds_read_b128 v[140:143], v3 offset:17408
    ds_read_b128 v[144:147], v3 offset:32768
    ds_read_b128 v[148:151], v3 offset:33792
    ds_read_b128 v[152:155], v3 offset:49152
    ds_read_b128 v[156:159], v3 offset:50176
    ds_read_b128 v[160:163], v4 offset:0
    ds_read_b128 v[164:167], v4 offset:1024
    ds_read_b128 v[168:171], v4 offset:16384
    ds_read_b128 v[172:175], v4 offset:17408
    ds_read_b128 v[176:179], v4 offset:32768
    ds_read_b128 v[180:183], v4 offset:33792
    ds_read_b128 v[184:187], v4 offset:49152
    ds_read_b128 v[188:191], v4 offset:50176
    s_waitcnt lgkmcnt(0)
    v_pk_add_f32 v[128:129], v[128:129], v[160:161]
    v_pk_add_f32 v[130:131], v[130:131], v[162:163]
    v_pk_add_f32 v[132:133], v[132:133], v[164:165]
    v_pk_add_f32 v[134:135], v[134:135], v[166:167]
    v_pk_add_f32 v[136:137], v[136:137], v[168:169]
    v_pk_add_f32 v[138:139], v[138:139], v[170:171]
    v_pk_add_f32 v[140:141], v[140:141], v[172:173]
    v_pk_add_f32 v[142:143], v[142:143], v[174:175]
    v_pk_add_f32 v[144:145], v[144:145], v[176:177]
    v_pk_add_f32 v[146:147], v[146:147], v[178:179]
    v_pk_add_f32 v[148:149], v[148:149], v[180:181]
    v_pk_add_f32 v[150:151], v[150:151], v[182:183]
    v_pk_add_f32 v[152:153], v[152:153], v[184:185]
    v_pk_add_f32 v[154:155], v[154:155], v[186:187]
    v_pk_add_f32 v[156:157], v[156:157], v[188:189]
    v_pk_add_f32 v[158:159], v[158:159], v[190:191]
    v_pk_add_f32 v[128:129], v[128:129], v[144:145]
    v_pk_add_f32 v[130:131], v[130:131], v[146:147]
    v_pk_add_f32 v[132:133], v[132:133], v[148:149]
    v_pk_add_f32 v[134:135], v[134:135], v[150:151]
    v_pk_add_f32 v[136:137], v[136:137], v[152:153]
    v_pk_add_f32 v[138:139], v[138:139], v[154:155]
    v_pk_add_f32 v[140:141], v[140:141], v[156:157]
    v_pk_add_f32 v[142:143], v[142:143], v[158:159]
    v_pk_add_f32 v[128:129], v[128:129], v[136:137]
    v_pk_add_f32 v[130:131], v[130:131], v[138:139]
    v_pk_add_f32 v[132:133], v[132:133], v[140:141]
    v_pk_add_f32 v[134:135], v[134:135], v[142:143]
    s_lshl_b32 s43, s41, 6
    s_bfe_u32 s44, s40, 0x10001
    s_lshl_b32 s44, s44, 5
    s_add_u32 s43, s43, s44
    v_and_b32 v2, 31, v1
    v_add_u32 v2, s43, v2
    s_movk_i32 s44, 1152
    v_mul_lo_u32 v2, v2, s44
    s_lshl_b32 s43, s42, 7
    s_lshr_b32 s44, s40, 2
    s_lshl_b32 s44, s44, 6
    s_add_u32 s43, s43, s44
    s_and_b32 s44, s40, 1
    s_lshl_b32 s44, s44, 5
    s_add_u32 s43, s43, s44
    v_add_u32 v2, s43, v2
    v_lshrrev_b32 v3, 5, v1
    v_lshl_add_u32 v13, v3, 4, v2
    v_cvt_pk_bf16_f32 v16, v128, v129
    v_cvt_pk_bf16_f32 v17, v130, v131
    v_cvt_pk_bf16_f32 v18, v132, v133
    v_cvt_pk_bf16_f32 v19, v134, v135
    s_nop 1
    v_permlane32_swap_b32 v16, v18
    v_permlane32_swap_b32 v17, v19
    s_nop 1
    buffer_store_dwordx4 v[16:19], v13, s[28:31], 0 offen
oproj_end:
    s_endpgm
.section .rodata,"a"
.p2align 6
.amdhsa_kernel attn_kernel
  .amdhsa_next_free_vgpr 168
  .amdhsa_next_free_sgpr 102
  .amdhsa_accum_offset 168
  .amdhsa_group_segment_fixed_size 0
  .amdhsa_kernarg_size 64
  .amdhsa_user_sgpr_count 2
  .amdhsa_user_sgpr_kernarg_segment_ptr 1
  .amdhsa_system_sgpr_workgroup_id_x 1
.end_amdhsa_kernel
.p2align 6
.amdhsa_kernel oproj_kernel
  .amdhsa_next_free_vgpr 192
  .amdhsa_next_free_sgpr 102
  .amdhsa_accum_offset 192
  .amdhsa_group_segment_fixed_size 0
  .amdhsa_kernarg_size 64
  .amdhsa_user_sgpr_count 2
  .amdhsa_user_sgpr_kernarg_segment_ptr 1
  .amdhsa_system_sgpr_workgroup_id_x 1
.end_amdhsa_kernel
```
